```python
import torch

def _softmax(x, axis=-1):
    return torch.softmax(x, dim=axis)
def _gelu(x):
    return torch.nn.functional.gelu(x, approximate="tanh")
def _silu(x):
    return torch.nn.functional.silu(x)
def _sigmoid(x):
    return torch.sigmoid(x)
def _layernorm(x, axis=-1, eps=1e-5):
    m = x.mean(dim=axis, keepdim=True)
    v = x.var(dim=axis, keepdim=True, unbiased=False)
    return (x - m) / torch.sqrt(v + eps)
def _scatter_add(tgt, idx, src, axis=0):
    return tgt.clone().index_add_(axis, idx, src)
def _segment_sum(src, seg, n):
    out = torch.zeros((n,) + src.shape[1:], dtype=src.dtype)
    return out.index_add_(0, seg, src)
def _pad(x, pw):
    flat = tuple(v for pair in reversed(pw) for v in pair)
    return torch.nn.functional.pad(x, flat)

kernel_name = 'interleave_layers__sliding_block_cached__sliding_block_cached__decode'

def setup_inputs():

    _w = (lambda a: (lambda t: t.to(torch.bfloat16) if t.is_floating_point() else t)(torch.as_tensor(a)))
    def _A_setup():
        B, Sq, D = 4, 1, 512
        Hq, Hkv, Sk, Dh = 32, 8, 4096, 128
        assert Hq % Hkv == 0, (Hq, Hkv)
        return {
            "x": _w((lambda *s: torch.randn(*s, dtype=torch.bfloat16) * 0.05)(B, Sq, D)),
            "k_cache": _w((lambda *s: torch.randn(*s, dtype=torch.bfloat16) * 0.8)(B, Hkv, Sk, Dh)),
            "v_cache": _w((lambda *s: torch.randn(*s, dtype=torch.bfloat16) * 3.2)(B, Hkv, Sk, Dh)),
            "wq": _w((lambda *s: torch.randn(*s, dtype=torch.bfloat16) * 0.8)(D, Hq * Dh) * (D ** -0.5)),
            "wo": _w((lambda *s: torch.randn(*s, dtype=torch.bfloat16) * 3.2)(Hq * Dh, D) * ((Hq * Dh) ** -0.5)),
        }
    _A_in = _A_setup()

    def _B_setup():
        B, Sq, D = 4, 1, 512
        Hq, Hkv, Sk, Dh = 32, 8, 4096, 128
        assert Hq % Hkv == 0, (Hq, Hkv)
        return {
            "x": _w((lambda *s: torch.randn(*s, dtype=torch.bfloat16) * 0.05)(B, Sq, D)),
            "k_cache": _w((lambda *s: torch.randn(*s, dtype=torch.bfloat16) * 1.6)(B, Hkv, Sk, Dh)),
            "v_cache": _w((lambda *s: torch.randn(*s, dtype=torch.bfloat16) * 1.6)(B, Hkv, Sk, Dh)),
            "wq": _w((lambda *s: torch.randn(*s, dtype=torch.bfloat16) * 1.6)(D, Hq * Dh) * (D ** -0.5)),
            "wo": _w((lambda *s: torch.randn(*s, dtype=torch.bfloat16) * 1.6)(Hq * Dh, D) * ((Hq * Dh) ** -0.5)),
        }
    _B_in = _B_setup()

    return {
        "A_x": _A_in["x"],
        "A_k_cache": _A_in["k_cache"],
        "A_v_cache": _A_in["v_cache"],
        "A_wq": _A_in["wq"],
        "A_wo": _A_in["wo"],
        "B_x": _B_in["x"],
        "B_k_cache": _B_in["k_cache"],
        "B_v_cache": _B_in["v_cache"],
        "B_wq": _B_in["wq"],
        "B_wo": _B_in["wo"],
    }

def reference(A_x, A_k_cache, A_v_cache, A_wq, A_wo, B_x, B_k_cache, B_v_cache, B_wq, B_wo):
    def _A_ref(x, k_cache, v_cache, wq, wo):
        B, Sq, D = x.shape
        Hq, Dh = 32, 128
        Hkv, Sk = k_cache.shape[1], k_cache.shape[2]
        W = min(4096, max(256, Sk // 4))
        rep = Hq // Hkv
        q = (lambda x, *d: x.permute(*d))((x @ wq).reshape(B, Sq, Hq, Dh), 0, 2, 1, 3)
        k = (lambda x, n, axis: torch.repeat_interleave(x, n, dim=axis))(k_cache[:, :, Sk - W:, :], rep, axis=1)
        v = (lambda x, n, axis: torch.repeat_interleave(x, n, dim=axis))(v_cache[:, :, Sk - W:, :], rep, axis=1)
        scores = torch.einsum("bhqd,bhkd->bhqk", q, k) * (Dh ** -0.5)
        p = _softmax(scores, axis=-1)
        o = torch.einsum("bhqk,bhkd->bhqd", p, v)
        return (lambda x, *d: x.permute(*d))(o, 0, 2, 1, 3).reshape(B, Sq, Hq * Dh) @ wo

    def _B_ref(x, k_cache, v_cache, wq, wo):
        B, Sq, D = x.shape
        Hq, Dh = 32, 128
        Hkv, Sk = k_cache.shape[1], k_cache.shape[2]
        W = min(4096, max(256, Sk // 4))
        rep = Hq // Hkv
        q = (lambda x, *d: x.permute(*d))((x @ wq).reshape(B, Sq, Hq, Dh), 0, 2, 1, 3)
        k = (lambda x, n, axis: torch.repeat_interleave(x, n, dim=axis))(k_cache[:, :, Sk - W:, :], rep, axis=1)
        v = (lambda x, n, axis: torch.repeat_interleave(x, n, dim=axis))(v_cache[:, :, Sk - W:, :], rep, axis=1)
        scores = torch.einsum("bhqd,bhkd->bhqk", q, k) * (Dh ** -0.5)
        p = _softmax(scores, axis=-1)
        o = torch.einsum("bhqk,bhkd->bhqd", p, v)
        return (lambda x, *d: x.permute(*d))(o, 0, 2, 1, 3).reshape(B, Sq, Hq * Dh) @ wo

    x = A_x
    x = x + _A_ref(_layernorm(x, axis=-1), A_k_cache, A_v_cache, A_wq, A_wo)
    x = x + _B_ref(_layernorm(x, axis=-1), B_k_cache, B_v_cache, B_wq, B_wo)
    x = x + _A_ref(_layernorm(x, axis=-1), A_k_cache, A_v_cache, A_wq, A_wo)
    x = x + _B_ref(_layernorm(x, axis=-1), B_k_cache, B_v_cache, B_wq, B_wo)
    return x
```

```asm
; @launch grid=(256,1,1) block=(512,1,1) lds=137216
.amdgcn_target "amdgcn-amd-amdhsa--gfx950"
.text
.globl interleave_layers__sliding_block_cached__sliding_block_cached__decode_kernel
.p2align 8
.type interleave_layers__sliding_block_cached__sliding_block_cached__decode_kernel,@function
interleave_layers__sliding_block_cached__sliding_block_cached__decode_kernel:

    s_cmp_ge_u32 s2, 256
    s_cbranch_scc1 L_end
    v_lshrrev_b32 v28, 6, v0

    s_and_b32 s3, s2, 7
    s_bfe_u32 s55, s2, 0x30005
    s_lshl_b32 s55, s55, 3
    s_or_b32 s3, s3, s55
    s_bfe_u32 s55, s2, 0x20003
    s_lshl_b32 s55, s55, 6
    s_or_b32 s3, s3, s55
    s_xor_b32 s2, s3, 0

    s_load_dwordx2 s[40:41], s[0:1], 96
    s_bfe_u32 s8, s2, 0x10003
    s_lshl_b32 s3, s8, 4
    s_add_u32 s55, s3, 8
    s_load_dwordx4 s[32:35], s[0:1], s55
    v_readfirstlane_b32 s7, v28
    s_add_u32 s56, s3, 48
    s_load_dwordx4 s[36:39], s[0:1], s56
    s_load_dwordx2 s[44:45], s[0:1], 0
    s_load_dwordx2 s[42:43], s[0:1], 80

    v_and_b32 v0, 63, v0
    s_and_b32 s4, s2, 7
    s_lshr_b32 s5, s2, 4
    s_lshr_b32 s6, s5, 1
    s_and_b32 s9, s5, 1
    s_lshr_b32 s49, s5, 2
    s_and_b32 s59, s7, 3
    s_mov_b32 s10, 0
    s_lshl_b32 s48, s4, 19
    s_add_u32 s48, s48, 0x200000
    s_mov_b32 s11, 32768
    s_mov_b32 s46, 0x05040100
    s_mov_b32 s47, 0x07060302
    s_mov_b32 s50, 0
    s_mov_b32 s51, -1
    s_getreg_b32 s62, hwreg(HW_REG_XCC_ID)

    v_mov_b32 v30, 0
    v_lshlrev_b32 v31, 2, v0
    v_add_u32 v31, 136192, v31
    s_mov_b64 exec, 0xffff
    ds_write_b32 v31, v30
    s_mov_b64 exec, -1

    s_lshl_b32 s58, s7, 14
    s_mul_i32 s63, s7, 0
    s_mul_i32 s55, s4, 0
    s_add_u32 s63, s63, s55
    s_mul_i32 s55, s5, 2048
    s_add_u32 s63, s63, s55
    s_mul_i32 s55, s49, 0
    s_add_u32 s63, s63, s55
    v_lshrrev_b32 v29, 4, v0
    s_lshl_b32 s3, s49, 3
    s_add_u32 s3, s3, s4
    s_lshl_b32 s3, s3, 12
    s_add_u32 s3, s3, 3072
    s_and_b32 s61, s5, 3
    s_lshl_b32 s55, s61, 8
    s_add_u32 s3, s3, s55
    s_mul_i32 s55, s59, 64
    s_add_u32 s3, s3, s55
    s_lshl_b32 s3, s3, 8
    v_lshlrev_b32 v16, 4, v0
    v_add_u32 v16, s3, v16
    v_lshlrev_b32 v12, 6, v29
    v_xor_b32 v12, v12, v16
    v_xor_b32 v13, 16, v12
    v_xor_b32 v14, 32, v12
    v_xor_b32 v15, 48, v12

    s_lshl_b32 s3, s6, 19
    s_lshl_b32 s55, s59, 17
    s_add_u32 s3, s3, s55
    s_lshl_b32 s55, s4, 10
    s_add_u32 s3, s3, s55
    s_lshl_b32 s55, s9, 9
    s_add_u32 s3, s3, s55
    v_lshrrev_b32 v4, 5, v0
    v_lshlrev_b32 v4, 16, v4
    v_and_b32 v30, 31, v0
    v_lshl_add_u32 v4, v30, 4, v4
    v_add_u32 v4, s3, v4

    s_mul_i32 s53, s8, 3
    s_lshr_b32 s53, 33554432, s53
    s_waitcnt lgkmcnt(0)
    s_mov_b32 s16, s32
    s_and_b32 s17, s33, 0xffff
    s_mov_b32 s18, s53
    s_mov_b32 s19, 0x20000
    s_mov_b32 s20, s34
    s_and_b32 s21, s35, 0xffff
    s_mov_b32 s22, s53
    s_mov_b32 s23, 0x20000
    s_mov_b32 s12, s40
    s_and_b32 s13, s41, 0xffff
    s_mov_b32 s14, 268435456
    s_mov_b32 s15, 0x20000
    s_mov_b32 s24, s36
    s_and_b32 s25, s37, 0xffff
    s_mov_b32 s26, s53
    s_mov_b32 s27, 0x20000
    s_mov_b32 s28, s38
    s_and_b32 s29, s39, 0xffff
    s_mov_b32 s30, s53
    s_mov_b32 s31, 0x20000
    s_mov_b32 s3, 0x1c0000
    s_load_dword s54, s[40:41], s3
    s_cmp_eq_u32 s8, 1
    s_cbranch_scc0 L_K
L_W:
    s_setprio 3
    s_cmp_ge_u32 s7, 4
    s_cbranch_scc0 L_WP
    s_mov_b32 s52, 0
    buffer_load_dwordx4 v[224:227], v4, s[16:19], s52 offen
    s_mov_b32 s52, 8192
    buffer_load_dwordx4 v[228:231], v4, s[16:19], s52 offen
    s_mov_b32 s52, 16384
    buffer_load_dwordx4 v[232:235], v4, s[16:19], s52 offen
    s_mov_b32 s52, 24576
    buffer_load_dwordx4 v[236:239], v4, s[16:19], s52 offen
    s_mov_b32 s52, 32768
    buffer_load_dwordx4 v[240:243], v4, s[16:19], s52 offen
    s_mov_b32 s52, 40960
    buffer_load_dwordx4 v[244:247], v4, s[16:19], s52 offen
    s_mov_b32 s52, 49152
    buffer_load_dwordx4 v[248:251], v4, s[16:19], s52 offen
    s_mov_b32 s52, 57344
    buffer_load_dwordx4 v[252:255], v4, s[16:19], s52 offen
    s_cmp_eq_u32 s9, 1
    s_cbranch_scc1 L_QG
    s_branch L_OG
L_WP:

    s_lshl_b32 s55, s59, 10
    v_lshlrev_b32 v200, 4, v0
    v_add_u32 v202, s55, v200
    s_lshl_b32 s56, s6, 7
    s_add_u32 s55, s55, s56
    v_lshlrev_b32 v201, 1, v0
    v_add_u32 v201, s55, v201
    global_load_dwordx4 v[204:207], v202, s[44:45]
    global_load_ushort v208, v201, s[44:45]

    s_cmp_eq_u32 s9, 1
    s_cbranch_scc1 L_Q
    s_branch L_O
L_K:
    s_cmp_ge_u32 s7, 4
    s_cbranch_scc1 L_KB
    s_setprio 1
    s_add_u32 m0, s58, 0
    s_add_u32 s52, s63, 0
    s_and_b32 s52, s52, 0x3c00
    buffer_load_dwordx4 v12, s[16:19], s52 offen nt lds
    s_add_u32 s52, s63, 0
    s_and_b32 s52, s52, 0x3c00
    buffer_load_dwordx4 v[192:195], v16, s[20:23], s52 offen nt
    s_add_u32 m0, s58, 1024
    s_add_u32 s52, s63, 1024
    s_and_b32 s52, s52, 0x3c00
    buffer_load_dwordx4 v13, s[16:19], s52 offen nt lds
    s_add_u32 s52, s63, 1024
    s_and_b32 s52, s52, 0x3c00
    buffer_load_dwordx4 v[196:199], v16, s[20:23], s52 offen nt
    s_add_u32 m0, s58, 2048
    s_add_u32 s52, s63, 2048
    s_and_b32 s52, s52, 0x3c00
    buffer_load_dwordx4 v14, s[16:19], s52 offen nt lds
    s_add_u32 s52, s63, 2048
    s_and_b32 s52, s52, 0x3c00
    buffer_load_dwordx4 v[200:203], v16, s[20:23], s52 offen nt
    s_add_u32 m0, s58, 3072
    s_add_u32 s52, s63, 3072
    s_and_b32 s52, s52, 0x3c00
    buffer_load_dwordx4 v15, s[16:19], s52 offen nt lds
    s_add_u32 s52, s63, 3072
    s_and_b32 s52, s52, 0x3c00
    buffer_load_dwordx4 v[204:207], v16, s[20:23], s52 offen nt
    s_add_u32 m0, s58, 4096
    s_add_u32 s52, s63, 4096
    s_and_b32 s52, s52, 0x3c00
    buffer_load_dwordx4 v12, s[16:19], s52 offen nt lds
    s_add_u32 s52, s63, 4096
    s_and_b32 s52, s52, 0x3c00
    buffer_load_dwordx4 v[208:211], v16, s[20:23], s52 offen nt
    s_add_u32 m0, s58, 5120
    s_add_u32 s52, s63, 5120
    s_and_b32 s52, s52, 0x3c00
    buffer_load_dwordx4 v13, s[16:19], s52 offen nt lds
    s_add_u32 s52, s63, 5120
    s_and_b32 s52, s52, 0x3c00
    buffer_load_dwordx4 v[212:215], v16, s[20:23], s52 offen nt

    s_barrier
    v_and_b32 v28, 15, v0
    v_lshrrev_b32 v29, 4, v0

    v_lshrrev_b32 v41, 2, v28
    v_and_b32 v42, 7, v0
    v_lshlrev_b32 v43, 4, v0
    v_lshlrev_b32 v1, 8, v41
    v_lshl_add_u32 v1, v29, 4, v1
    v_add_u32 v1, 131072, v1
    s_lshl_b32 s55, s59, 14
    v_lshlrev_b32 v2, 2, v0
    v_add_u32 v2, s55, v2
    v_add_u32 v17, 1280, v2
    s_lshl_b32 s55, s59, 2
    s_add_u32 s55, s55, 132096
    v_lshlrev_b32 v3, 4, v41
    v_add_u32 v3, s55, v3
    v_lshlrev_b32 v4, 4, v29
    v_add_u32 v4, s55, v4
    v_add_u32 v4, 64, v4
    s_lshl_b32 s55, s59, 4
    s_add_u32 s55, s55, 132096
    v_mov_b32 v6, s55
    s_lshl_b32 s55, s59, 6
    v_lshrrev_b32 v40, 3, v0
    v_mul_u32_u24 v5, 320, v40
    v_lshl_add_u32 v5, v42, 3, v5
    v_add_u32 v5, s55, v5
    s_lshl_b32 s3, s49, 2
    s_add_u32 s3, s3, s59
    s_lshl_b32 s55, s3, 10
    s_lshl_b32 s56, s61, 8
    s_add_u32 s56, s56, s55
    v_lshlrev_b32 v7, 4, v40
    v_and_b32 v40, 3, v0
    v_lshl_add_u32 v7, v40, 2, v7
    v_bfe_u32 v40, v0, 2, 1
    v_lshl_add_u32 v7, v40, 7, v7
    v_add_u32 v7, s56, v7
    s_lshl_b32 s55, s3, 11
    v_add_u32 v9, s55, v43
    s_lshl_b32 s55, s3, 7
    s_lshl_b32 s56, s61, 3
    s_add_u32 s55, s55, s56
    v_mov_b32 v8, s55
    s_mov_b32 s36, 0xaaaaaaaa
    s_mov_b32 s37, 0xaaaaaaaa
    s_mov_b32 s38, 0xcccccccc
    s_mov_b32 s39, 0xcccccccc
    s_lshl_b32 s55, s49, 8
    v_lshlrev_b32 v10, 4, v28
    v_add_u32 v10, s55, v10
    s_lshl_b32 s55, s59, 8
    s_add_u32 s55, s55, 131072
    v_lshlrev_b32 v11, 4, v28
    v_lshl_add_u32 v11, v29, 3, v11
    v_add_u32 v11, s55, v11
    v_lshlrev_b32 v40, 3, v0
    v_add_u32 v40, 136320, v40
    v_cndmask_b32 v11, v11, v40, s[50:51]

    v_and_b32 v43, 1, v28
    v_lshlrev_b32 v43, 4, v43
    v_mov_b32 v40, 0xffff
    v_lshlrev_b32 v40, v43, v40
    v_lshrrev_b32 v43, 1, v28

    v_cmp_eq_u32 vcc, 0, v43
    s_nop 1
    v_cndmask_b32 v24, 0, v40, vcc
    v_cmp_eq_u32 vcc, 1, v43
    s_nop 1
    v_cndmask_b32 v25, 0, v40, vcc
    v_cmp_eq_u32 vcc, 2, v43
    s_nop 1
    v_cndmask_b32 v26, 0, v40, vcc
    v_cmp_eq_u32 vcc, 3, v43
    s_nop 1
    v_cndmask_b32 v27, 0, v40, vcc

    v_lshlrev_b32 v30, 4, v0
    v_sub_u32 v20, v9, v30
    v_lshl_add_u32 v20, v20, 1, v30
    s_lshl_b32 s55, s59, 8
    s_add_u32 s55, s55, 131072
    v_lshlrev_b32 v19, 3, v0
    v_add_u32 v19, s55, v19

    s_add_u32 s57, s48, 0x50000
    s_add_u32 m0, s58, 6144
    s_add_u32 s52, s63, 6144
    s_and_b32 s52, s52, 0x3c00
    buffer_load_dwordx4 v14, s[16:19], s52 offen nt lds
    s_add_u32 s52, s63, 6144
    s_and_b32 s52, s52, 0x3c00
    buffer_load_dwordx4 v[216:219], v16, s[20:23], s52 offen nt
    s_add_u32 m0, s58, 7168
    s_add_u32 s52, s63, 7168
    s_and_b32 s52, s52, 0x3c00
    buffer_load_dwordx4 v15, s[16:19], s52 offen nt lds
    s_add_u32 s52, s63, 7168
    s_and_b32 s52, s52, 0x3c00
    buffer_load_dwordx4 v[220:223], v16, s[20:23], s52 offen nt

    s_add_u32 m0, s58, 8192
    s_add_u32 s52, s63, 8192
    s_and_b32 s52, s52, 0x3c00
    buffer_load_dwordx4 v12, s[16:19], s52 offen nt lds
    s_add_u32 s52, s63, 8192
    s_and_b32 s52, s52, 0x3c00
    buffer_load_dwordx4 v[224:227], v16, s[20:23], s52 offen nt
    s_add_u32 m0, s58, 9216
    s_add_u32 s52, s63, 9216
    s_and_b32 s52, s52, 0x3c00
    buffer_load_dwordx4 v13, s[16:19], s52 offen nt lds
    s_add_u32 s52, s63, 9216
    s_and_b32 s52, s52, 0x3c00
    buffer_load_dwordx4 v[228:231], v16, s[20:23], s52 offen nt

    s_add_u32 m0, s58, 10240
    s_add_u32 s52, s63, 10240
    s_and_b32 s52, s52, 0x3c00
    buffer_load_dwordx4 v14, s[16:19], s52 offen nt lds
    s_add_u32 s52, s63, 10240
    s_and_b32 s52, s52, 0x3c00
    buffer_load_dwordx4 v[232:235], v16, s[20:23], s52 offen nt
    s_add_u32 m0, s58, 11264
    s_add_u32 s52, s63, 11264
    s_and_b32 s52, s52, 0x3c00
    buffer_load_dwordx4 v15, s[16:19], s52 offen nt lds
    s_add_u32 s52, s63, 11264
    s_and_b32 s52, s52, 0x3c00
    buffer_load_dwordx4 v[236:239], v16, s[20:23], s52 offen nt

    s_add_u32 m0, s58, 12288
    s_add_u32 s52, s63, 12288
    s_and_b32 s52, s52, 0x3c00
    buffer_load_dwordx4 v12, s[16:19], s52 offen nt lds
    s_add_u32 s52, s63, 12288
    s_and_b32 s52, s52, 0x3c00
    buffer_load_dwordx4 v[240:243], v16, s[20:23], s52 offen nt
    s_add_u32 m0, s58, 13312
    s_add_u32 s52, s63, 13312
    s_and_b32 s52, s52, 0x3c00
    buffer_load_dwordx4 v13, s[16:19], s52 offen nt lds
    s_add_u32 s52, s63, 13312
    s_and_b32 s52, s52, 0x3c00
    buffer_load_dwordx4 v[244:247], v16, s[20:23], s52 offen nt

    s_add_u32 m0, s58, 14336
    s_add_u32 s52, s63, 14336
    s_and_b32 s52, s52, 0x3c00
    buffer_load_dwordx4 v14, s[16:19], s52 offen nt lds
    s_add_u32 s52, s63, 14336
    s_and_b32 s52, s52, 0x3c00
    buffer_load_dwordx4 v[248:251], v16, s[20:23], s52 offen nt
    s_add_u32 m0, s58, 15360
    s_add_u32 s52, s63, 15360
    s_and_b32 s52, s52, 0x3c00
    buffer_load_dwordx4 v15, s[16:19], s52 offen nt lds
    s_add_u32 s52, s63, 15360
    s_and_b32 s52, s52, 0x3c00
    buffer_load_dwordx4 v[252:255], v16, s[20:23], s52 offen nt

    v_mov_b32 v30, 136208
    v_mov_b32 v31, 1
    s_mov_b64 exec, 1
    ds_add_u32 v30, v31
    s_mov_b64 exec, -1
    v_mov_b32 v30, 136208
    s_mov_b32 s53, 0
Lf_1:
    ds_read_b32 v31, v30
    s_waitcnt lgkmcnt(0)
    v_readfirstlane_b32 s55, v31
    s_nop 0
    s_cmp_ge_u32 s55, 4
    s_cbranch_scc1 Lfd_2
    s_add_u32 s53, s53, 1
    s_cmp_lt_u32 s53, 0x200000
    s_cbranch_scc1 Lf_1
Lfd_2:
    buffer_load_dwordx4 v[44:47], v20, s[12:15], s57 offen offset:0 nt
    buffer_load_dwordx4 v[48:51], v20, s[12:15], s57 offen offset:1024 nt
    buffer_load_dwordx4 v[52:55], v20, s[12:15], s57 offen offset:2048 nt
    buffer_load_dwordx4 v[56:59], v20, s[12:15], s57 offen offset:3072 nt
    v_mov_b32 v30, 136192
    v_mov_b32 v31, 1
    s_mov_b64 exec, 1
    ds_add_u32 v30, v31
    s_mov_b64 exec, -1
    s_setprio 3

    s_mov_b32 s32, 0xffff0000
    s_mov_b32 s33, 0xffff0000
    v_cndmask_b32 v32, v24, v26, s[32:33]
    v_cndmask_b32 v34, v25, v27, s[32:33]
    v_and_b32 v32, 0x3f803f80, v32
    v_and_b32 v34, 0x3f803f80, v34
    v_mov_b32 v33, 0
    v_mov_b32 v35, 0

    v_and_b32 v28, 15, v0
    v_lshrrev_b32 v29, 4, v0

    v_lshrrev_b32 v30, 2, v28
    v_and_b32 v31, 3, v28
    v_lshl_add_u32 v31, v31, 2, v30
    v_xor_b32 v40, v29, v28
    v_lshlrev_b32 v40, 4, v40
    v_lshl_add_u32 v40, v31, 8, v40
    v_add_u32 v40, s58, v40

    v_xor_b32 v41, 64, v40
    v_xor_b32 v42, 128, v40
    v_xor_b32 v43, 192, v40
    s_waitcnt vmcnt(21)
    ds_read_b128 v[64:67], v40 offset:0
    ds_read_b128 v[68:71], v41 offset:0
    ds_read_b128 v[72:75], v42 offset:0
    ds_read_b128 v[76:79], v43 offset:0
    ds_read_b128 v[80:83], v40 offset:4096
    ds_read_b128 v[84:87], v41 offset:4096
    ds_read_b128 v[88:91], v42 offset:4096
    ds_read_b128 v[92:95], v43 offset:4096
    s_waitcnt vmcnt(32)
    v_perm_b32 v128, v196, v192, s46
    v_perm_b32 v132, v196, v192, s47
    v_perm_b32 v136, v197, v193, s46
    v_perm_b32 v140, v197, v193, s47
    v_perm_b32 v144, v198, v194, s46
    v_perm_b32 v148, v198, v194, s47
    v_perm_b32 v152, v199, v195, s46
    v_perm_b32 v156, v199, v195, s47
    s_waitcnt vmcnt(28)
    v_perm_b32 v129, v204, v200, s46
    v_perm_b32 v133, v204, v200, s47
    v_perm_b32 v137, v205, v201, s46
    v_perm_b32 v141, v205, v201, s47
    v_perm_b32 v145, v206, v202, s46
    v_perm_b32 v149, v206, v202, s47
    v_perm_b32 v153, v207, v203, s46
    v_perm_b32 v157, v207, v203, s47
    s_waitcnt vmcnt(24)
    v_perm_b32 v130, v212, v208, s46
    v_perm_b32 v134, v212, v208, s47
    v_perm_b32 v138, v213, v209, s46
    v_perm_b32 v142, v213, v209, s47
    v_perm_b32 v146, v214, v210, s46
    v_perm_b32 v150, v214, v210, s47
    v_perm_b32 v154, v215, v211, s46
    v_perm_b32 v158, v215, v211, s47
    s_waitcnt vmcnt(20)
    v_perm_b32 v131, v220, v216, s46
    v_perm_b32 v135, v220, v216, s47
    v_perm_b32 v139, v221, v217, s46
    v_perm_b32 v143, v221, v217, s47
    v_perm_b32 v147, v222, v218, s46
    v_perm_b32 v151, v222, v218, s47
    v_perm_b32 v155, v223, v219, s46
    v_perm_b32 v159, v223, v219, s47
    s_waitcnt vmcnt(5)
    ds_read_b128 v[96:99], v40 offset:8192
    ds_read_b128 v[100:103], v41 offset:8192
    ds_read_b128 v[104:107], v42 offset:8192
    ds_read_b128 v[108:111], v43 offset:8192
    ds_read_b128 v[112:115], v40 offset:12288
    ds_read_b128 v[116:119], v41 offset:12288
    ds_read_b128 v[120:123], v42 offset:12288
    ds_read_b128 v[124:127], v43 offset:12288
    s_waitcnt vmcnt(16)
    v_perm_b32 v160, v228, v224, s46
    v_perm_b32 v164, v228, v224, s47
    v_perm_b32 v168, v229, v225, s46
    v_perm_b32 v172, v229, v225, s47
    v_perm_b32 v176, v230, v226, s46
    v_perm_b32 v180, v230, v226, s47
    v_perm_b32 v184, v231, v227, s46
    v_perm_b32 v188, v231, v227, s47
    s_waitcnt vmcnt(12)
    v_perm_b32 v161, v236, v232, s46
    v_perm_b32 v165, v236, v232, s47
    v_perm_b32 v169, v237, v233, s46
    v_perm_b32 v173, v237, v233, s47
    v_perm_b32 v177, v238, v234, s46
    v_perm_b32 v181, v238, v234, s47
    v_perm_b32 v185, v239, v235, s46
    v_perm_b32 v189, v239, v235, s47
    s_waitcnt vmcnt(8)
    v_perm_b32 v162, v244, v240, s46
    v_perm_b32 v166, v244, v240, s47
    v_perm_b32 v170, v245, v241, s46
    v_perm_b32 v174, v245, v241, s47
    v_perm_b32 v178, v246, v242, s46
    v_perm_b32 v182, v246, v242, s47
    v_perm_b32 v186, v247, v243, s46
    v_perm_b32 v190, v247, v243, s47
    s_waitcnt vmcnt(4)
    v_perm_b32 v163, v252, v248, s46
    v_perm_b32 v167, v252, v248, s47
    v_perm_b32 v171, v253, v249, s46
    v_perm_b32 v175, v253, v249, s47
    v_perm_b32 v179, v254, v250, s46
    v_perm_b32 v183, v254, v250, s47
    v_perm_b32 v187, v255, v251, s46
    v_perm_b32 v191, v255, v251, s47
    v_mov_b32 v232, 0x3f803f80
    v_mov_b32 v233, 0x3f803f80
    v_mov_b32 v234, 0x3f803f80
    v_mov_b32 v235, 0x3f803f80
    s_waitcnt lgkmcnt(0)
    s_add_u32 s56, s54, 1
    s_and_b32 s56, s56, 0xbfffbfff
    s_mov_b32 s53, 0
    s_branch Lpw_5
Lp_3:
    buffer_load_dwordx4 v[44:47], v20, s[12:15], s57 offen offset:0 sc1
    buffer_load_dwordx4 v[48:51], v20, s[12:15], s57 offen offset:1024 sc1
    buffer_load_dwordx4 v[52:55], v20, s[12:15], s57 offen offset:2048 sc1
    buffer_load_dwordx4 v[56:59], v20, s[12:15], s57 offen offset:3072 sc1
Lpw_5:
    s_waitcnt vmcnt(0)
    v_mfma_f32_16x16x32_bf16 v[36:39], v[32:35], v[44:47], 0
    v_mfma_f32_16x16x32_bf16 v[36:39], v[32:35], v[48:51], v[36:39]
    v_mfma_f32_16x16x32_bf16 v[36:39], v[32:35], v[52:55], v[36:39]
    v_mfma_f32_16x16x32_bf16 v[36:39], v[32:35], v[56:59], v[36:39]
    v_max3_u32 v28, v45, v47, v49
    v_min3_u32 v29, v45, v47, v49
    v_max3_u32 v28, v28, v51, v53
    v_min3_u32 v29, v29, v51, v53
    v_max3_u32 v28, v28, v55, v57
    v_min3_u32 v29, v29, v55, v57
    v_xor_b32 v28, s56, v28
    v_xor_b32 v29, s56, v29
    v_xor_b32 v30, s56, v59
    v_or3_b32 v28, v28, v29, v30
    v_cmp_ne_u32 vcc, 0, v28
    s_cbranch_vccz Lpd_4
    s_add_u32 s53, s53, 1
    s_cmp_ge_u32 s53, 6
    s_cselect_b32 s55, 0x800000, 0
    s_xor_b32 s57, s57, s55
    s_cmp_lt_u32 s53, s11
    s_cbranch_scc1 Lp_3
    s_mov_b32 s11, 0
Lpd_4:
    v_cvt_pk_bf16_f32 v36, v36, v37
    v_cvt_pk_bf16_f32 v37, v38, v39
    s_mov_b32 exec_hi, 0
    ds_write_b64 v19, v[36:37]
    s_mov_b32 exec_hi, -1
    s_waitcnt vmcnt(0) lgkmcnt(0)
    s_barrier
    ds_read_b128 v[192:195], v1 offset:0
    ds_read_b128 v[196:199], v1 offset:64
    ds_read_b128 v[200:203], v1 offset:128
    ds_read_b128 v[204:207], v1 offset:192
    s_mov_b32 s55, 0x3e0293ee
    s_waitcnt lgkmcnt(3)
    v_mfma_f32_16x16x32_bf16 v[208:211], v[64:67], v[192:195], 0
    v_mfma_f32_16x16x32_bf16 v[212:215], v[80:83], v[192:195], 0
    v_mfma_f32_16x16x32_bf16 v[216:219], v[96:99], v[192:195], 0
    v_mfma_f32_16x16x32_bf16 v[220:223], v[112:115], v[192:195], 0
    s_waitcnt lgkmcnt(2)
    v_mfma_f32_16x16x32_bf16 v[208:211], v[68:71], v[196:199], v[208:211]
    v_mfma_f32_16x16x32_bf16 v[212:215], v[84:87], v[196:199], v[212:215]
    v_mfma_f32_16x16x32_bf16 v[216:219], v[100:103], v[196:199], v[216:219]
    v_mfma_f32_16x16x32_bf16 v[220:223], v[116:119], v[196:199], v[220:223]
    s_waitcnt lgkmcnt(1)
    v_mfma_f32_16x16x32_bf16 v[208:211], v[72:75], v[200:203], v[208:211]
    v_mfma_f32_16x16x32_bf16 v[212:215], v[88:91], v[200:203], v[212:215]
    v_mfma_f32_16x16x32_bf16 v[216:219], v[104:107], v[200:203], v[216:219]
    v_mfma_f32_16x16x32_bf16 v[220:223], v[120:123], v[200:203], v[220:223]
    s_waitcnt lgkmcnt(0)
    v_mfma_f32_16x16x32_bf16 v[208:211], v[76:79], v[204:207], v[208:211]
    v_mfma_f32_16x16x32_bf16 v[212:215], v[92:95], v[204:207], v[212:215]
    v_mfma_f32_16x16x32_bf16 v[216:219], v[108:111], v[204:207], v[216:219]
    v_mfma_f32_16x16x32_bf16 v[220:223], v[124:127], v[204:207], v[220:223]
    s_nop 4
    v_max3_f32 v248, v208, v209, v210
    v_max3_f32 v248, v248, v211, v212
    v_max3_f32 v249, v213, v214, v215
    v_max3_f32 v248, v248, v216, v217
    v_max3_f32 v249, v249, v218, v219
    v_max3_f32 v248, v248, v220, v221
    v_max3_f32 v249, v249, v222, v223
    v_max_f32 v248, v248, v249
    v_mov_b32 v249, v248
    v_cndmask_b32 v240, v208, v210, s[36:37]
    v_cndmask_b32 v241, v209, v211, s[36:37]
    v_cndmask_b32 v242, v212, v214, s[36:37]
    v_cndmask_b32 v243, v213, v215, s[36:37]
    v_permlane16_swap_b32 v248, v249
    v_max_f32 v248, v248, v249
    v_mov_b32 v249, v248
    v_cndmask_b32 v244, v216, v218, s[36:37]
    v_cndmask_b32 v245, v217, v219, s[36:37]
    v_cndmask_b32 v246, v220, v222, s[36:37]
    v_cndmask_b32 v247, v221, v223, s[36:37]
    v_permlane32_swap_b32 v248, v249
    v_max_f32 v248, v248, v249
    v_mul_f32 v248, s55, v248
    ds_write_b32 v3, v248
    v_cndmask_b32 v240, v240, v242, s[38:39]
    v_cndmask_b32 v241, v241, v243, s[38:39]
    v_cndmask_b32 v244, v244, v246, s[38:39]
    v_cndmask_b32 v245, v245, v247, s[38:39]
    v_fma_f32 v240, v240, s55, -v248
    v_fma_f32 v241, v241, s55, -v248
    v_fma_f32 v244, v244, s55, -v248
    v_fma_f32 v245, v245, s55, -v248
    v_exp_f32 v240, v240
    v_exp_f32 v241, v241
    v_exp_f32 v244, v244
    v_exp_f32 v245, v245
    s_waitcnt lgkmcnt(0)
    s_barrier
    v_cvt_pk_bf16_f32 v240, v240, v241
    v_cvt_pk_bf16_f32 v244, v244, v245
    s_nop 0
    v_mov_b32_dpp v224, v240 quad_perm:[0,0,0,0] row_mask:0xf bank_mask:0xf
    v_mov_b32_dpp v225, v240 quad_perm:[1,1,1,1] row_mask:0xf bank_mask:0xf
    v_mov_b32_dpp v226, v240 quad_perm:[2,2,2,2] row_mask:0xf bank_mask:0xf
    v_mov_b32_dpp v227, v240 quad_perm:[3,3,3,3] row_mask:0xf bank_mask:0xf
    v_mov_b32_dpp v228, v244 quad_perm:[0,0,0,0] row_mask:0xf bank_mask:0xf
    v_mov_b32_dpp v229, v244 quad_perm:[1,1,1,1] row_mask:0xf bank_mask:0xf
    v_mov_b32_dpp v230, v244 quad_perm:[2,2,2,2] row_mask:0xf bank_mask:0xf
    v_mov_b32_dpp v231, v244 quad_perm:[3,3,3,3] row_mask:0xf bank_mask:0xf
    v_mfma_f32_16x16x32_bf16 v[32:35], v[224:227], v[128:131], 0
    v_mfma_f32_16x16x32_bf16 v[36:39], v[224:227], v[132:135], 0
    v_mfma_f32_16x16x32_bf16 v[40:43], v[224:227], v[136:139], 0
    v_mfma_f32_16x16x32_bf16 v[44:47], v[224:227], v[140:143], 0
    v_mfma_f32_16x16x32_bf16 v[48:51], v[224:227], v[144:147], 0
    v_mfma_f32_16x16x32_bf16 v[52:55], v[224:227], v[148:151], 0
    v_mfma_f32_16x16x32_bf16 v[56:59], v[224:227], v[152:155], 0
    v_mfma_f32_16x16x32_bf16 v[60:63], v[224:227], v[156:159], 0
    v_mfma_f32_16x16x32_bf16 v[236:239], v[224:227], v[232:235], 0
    v_mfma_f32_16x16x32_bf16 v[32:35], v[228:231], v[160:163], v[32:35]
    v_mfma_f32_16x16x32_bf16 v[36:39], v[228:231], v[164:167], v[36:39]
    v_mfma_f32_16x16x32_bf16 v[40:43], v[228:231], v[168:171], v[40:43]
    v_mfma_f32_16x16x32_bf16 v[44:47], v[228:231], v[172:175], v[44:47]
    v_mfma_f32_16x16x32_bf16 v[48:51], v[228:231], v[176:179], v[48:51]
    v_mfma_f32_16x16x32_bf16 v[52:55], v[228:231], v[180:183], v[52:55]
    v_mfma_f32_16x16x32_bf16 v[56:59], v[228:231], v[184:187], v[56:59]
    v_mfma_f32_16x16x32_bf16 v[60:63], v[228:231], v[188:191], v[60:63]
    v_mfma_f32_16x16x32_bf16 v[236:239], v[228:231], v[232:235], v[236:239]
    s_nop 0
    ds_write2_b32 v2, v32, v36 offset0:0 offset1:80
    s_nop 0
    ds_write2_b32 v2, v40, v44 offset0:160 offset1:240
    s_nop 0
    ds_write2_b32 v17, v48, v52 offset0:0 offset1:80
    s_nop 0
    ds_write2_b32 v17, v56, v60 offset0:160 offset1:240
    ds_write_b32 v4, v236
    s_waitcnt lgkmcnt(0)
    s_barrier
    s_barrier
    s_branch L_pg1
.p2align 12
L_pg1:
    v_mov_b32 v30, 136260
    ds_read_b32 v30, v30
    s_waitcnt lgkmcnt(0)
    v_readfirstlane_b32 s10, v30
    s_nop 0
    s_cmp_eq_u32 s10, 0
    s_cselect_b32 s55, 0x800000, 0
    s_add_u32 s48, s48, s55
    v_mov_b32 v30, 136212
    s_mov_b32 s53, 0
Lf_6:
    ds_read_b32 v31, v30
    s_waitcnt lgkmcnt(0)
    v_readfirstlane_b32 s55, v31
    s_nop 0
    s_cmp_ge_u32 s55, 4
    s_cbranch_scc1 Lfd_7
    s_add_u32 s53, s53, 1
    s_cmp_lt_u32 s53, 0x200000
    s_cbranch_scc1 Lf_6
Lfd_7:
    v_and_b32 v60, 0x3f803f80, v24
    v_and_b32 v61, 0x3f803f80, v25
    v_and_b32 v62, 0x3f803f80, v26
    v_and_b32 v63, 0x3f803f80, v27
    s_lshl_b32 s55, s49, 13
    s_add_u32 s32, s48, 0xa000
    s_sub_u32 s32, s32, s55
    s_add_u32 s52, s48, 0xe000
    s_add_u32 s57, s48, 0x0
    v_mov_b32 v44, 0x3727c5ac
    buffer_load_dwordx4 v[192:195], v9, s[12:15], s32 offen offset:0 sc1
    buffer_load_dwordx4 v[196:199], v9, s[12:15], s32 offen offset:1024 sc1
    s_mov_b32 s53, 0
Lp_8:
    buffer_load_dwordx4 v[40:43], v10, s[12:15], s52 offen offset:0 sc1
    buffer_load_dwordx4 v[32:35], v9, s[12:15], s57 offen offset:0 sc1
    buffer_load_dwordx4 v[36:39], v9, s[12:15], s57 offen offset:1024 sc1
    s_waitcnt vmcnt(2)
    v_max3_u32 v28, v40, v41, v42
    v_max_u32 v28, v28, v43
    v_cmp_eq_u32 vcc, -1, v28
    s_cbranch_vccz Lpd_9
    s_add_u32 s53, s53, 1
    s_cmp_lt_u32 s53, s11
    s_cbranch_scc1 Lp_8
    s_mov_b32 s11, 0
Lpd_9:
    v_max3_u32 v28, v192, v193, v194
    v_max3_u32 v28, v28, v195, v196
    v_max3_u32 v28, v28, v197, v198
    v_max_u32 v28, v28, v199
    v_cmp_eq_u32 vcc, -1, v28
    s_cbranch_vccz Lcs_10
    s_mov_b32 s53, 0
Lp_11:
    buffer_load_dwordx4 v[192:195], v9, s[12:15], s32 offen offset:0 sc1
    buffer_load_dwordx4 v[196:199], v9, s[12:15], s32 offen offset:1024 sc1
    s_waitcnt vmcnt(0)
    v_max3_u32 v28, v192, v193, v194
    v_max3_u32 v28, v28, v195, v196
    v_max3_u32 v28, v28, v197, v198
    v_max_u32 v28, v28, v199
    v_cmp_eq_u32 vcc, -1, v28
    s_cbranch_vccz Lpd_12
    s_add_u32 s53, s53, 1
    s_cmp_lt_u32 s53, s11
    s_cbranch_scc1 Lp_11
    s_mov_b32 s11, 0
Lpd_12:
Lcs_10:
    v_mfma_f32_16x16x32_bf16 v[20:23], v[60:63], v[192:195], 0
    v_mfma_f32_16x16x32_bf16 v[20:23], v[60:63], v[196:199], v[20:23]
    v_add_f32 v40, v40, v42
    v_add_f32 v41, v41, v43
    s_nop 0
    v_add_f32_dpp v40, v40, v40 quad_perm:[1,0,3,2] row_mask:0xf bank_mask:0xf
    v_add_f32_dpp v41, v41, v41 quad_perm:[1,0,3,2] row_mask:0xf bank_mask:0xf
    s_nop 0
    v_add_f32_dpp v40, v40, v40 quad_perm:[2,3,0,1] row_mask:0xf bank_mask:0xf
    v_add_f32_dpp v41, v41, v41 quad_perm:[2,3,0,1] row_mask:0xf bank_mask:0xf
    s_nop 0
    v_add_f32_dpp v40, v40, v40 row_half_mirror row_mask:0xf bank_mask:0xf
    v_add_f32_dpp v41, v41, v41 row_half_mirror row_mask:0xf bank_mask:0xf
    s_nop 0
    v_add_f32_dpp v40, v40, v40 row_mirror row_mask:0xf bank_mask:0xf
    v_add_f32_dpp v41, v41, v41 row_mirror row_mask:0xf bank_mask:0xf
    v_mul_f32 v40, 0x3b000000, v40
    v_fmac_f32 v44, 0x3b000000, v41
    v_fma_f32 v41, -v40, v40, v44
    v_max_f32 v41, 0x3727c5ac, v41
    buffer_load_dwordx4 v[216:219], v9, s[12:15], s57 offen offset:0 sc1
    buffer_load_dwordx4 v[220:223], v9, s[12:15], s57 offen offset:1024 sc1
    v_rsq_f32 v41, v41
    v_mul_f32_e64 v48, -v40, v20
    v_mul_f32_e64 v49, -v40, v21
    v_mul_f32_e64 v50, -v40, v22
    v_mul_f32_e64 v51, -v40, v23
    s_mov_b32 s53, 0
Lq_13:
    s_waitcnt vmcnt(2)
    v_mfma_f32_16x16x32_bf16 v[52:55], v[60:63], v[32:35], v[48:51]
    v_mfma_f32_16x16x32_bf16 v[52:55], v[60:63], v[36:39], v[52:55]
    v_max3_u32 v28, v32, v33, v34
    v_max3_u32 v28, v28, v35, v36
    v_max3_u32 v28, v28, v37, v38
    v_max_u32 v28, v28, v39
    v_cmp_eq_u32 vcc, -1, v28
    s_cbranch_vccz Lqd_14
    buffer_load_dwordx4 v[32:35], v9, s[12:15], s57 offen offset:0 sc1
    buffer_load_dwordx4 v[36:39], v9, s[12:15], s57 offen offset:1024 sc1
    s_waitcnt vmcnt(2)
    v_mfma_f32_16x16x32_bf16 v[52:55], v[60:63], v[216:219], v[48:51]
    v_mfma_f32_16x16x32_bf16 v[52:55], v[60:63], v[220:223], v[52:55]
    v_max3_u32 v28, v216, v217, v218
    v_max3_u32 v28, v28, v219, v220
    v_max3_u32 v28, v28, v221, v222
    v_max_u32 v28, v28, v223
    v_cmp_eq_u32 vcc, -1, v28
    s_cbranch_vccz Lqd_14
    buffer_load_dwordx4 v[216:219], v9, s[12:15], s57 offen offset:0 sc1
    buffer_load_dwordx4 v[220:223], v9, s[12:15], s57 offen offset:1024 sc1
    s_add_u32 s53, s53, 1
    s_cmp_lt_u32 s53, s11
    s_cbranch_scc1 Lq_13
    s_mov_b32 s11, 0
Lqd_14:
    s_nop 1
    v_pk_mul_f32 v[52:53], v[52:53], v[40:41] op_sel:[0,1] op_sel_hi:[1,1]
    v_pk_mul_f32 v[54:55], v[54:55], v[40:41] op_sel:[0,1] op_sel_hi:[1,1]
    v_cvt_pk_bf16_f32 v52, v52, v53
    v_cvt_pk_bf16_f32 v53, v54, v55
    ds_write_b64 v11, v[52:53]
    s_add_u32 s35, s48, 0xc800
    s_add_u32 s57, s48, 0x13000
    s_waitcnt lgkmcnt(0)
    s_barrier
    s_barrier
    ds_read_b128 v[200:203], v6
    s_waitcnt lgkmcnt(0)
    v_max3_f32 v208, v200, v201, v202
    v_max_f32 v208, v208, v203
    s_cmp_eq_u32 s10, 0
    s_cbranch_scc1 Lst_15
    s_mov_b64 exec, 1
    buffer_store_dword v208, v8, s[12:15], s35 offen
    s_mov_b64 exec, -1
    s_branch Lst_16
Lst_15:
    s_mov_b64 exec, 1
    buffer_store_dword v208, v8, s[12:15], s35 offen sc1
    s_mov_b64 exec, -1
Lst_16:
    v_sub_f32 v200, v200, v208
    v_sub_f32 v201, v201, v208
    v_sub_f32 v202, v202, v208
    v_sub_f32 v203, v203, v208
    v_exp_f32 v200, v200
    v_exp_f32 v201, v201
    v_exp_f32 v202, v202
    v_exp_f32 v203, v203
    s_barrier
    ds_read_b64 v[192:193], v5 offset:0
    ds_read_b64 v[194:195], v5 offset:16384
    ds_read_b64 v[196:197], v5 offset:32768
    ds_read_b64 v[198:199], v5 offset:49152
    ds_read_b128 v[204:207], v6 offset:64
    s_waitcnt lgkmcnt(4)
    v_pk_mul_f32 v[210:211], v[192:193], v[200:201] op_sel:[0,0] op_sel_hi:[1,0]
    s_waitcnt lgkmcnt(3)
    v_pk_fma_f32 v[210:211], v[194:195], v[200:201], v[210:211] op_sel:[0,1,0] op_sel_hi:[1,1,1]
    s_waitcnt lgkmcnt(2)
    v_pk_fma_f32 v[210:211], v[196:197], v[202:203], v[210:211] op_sel:[0,0,0] op_sel_hi:[1,0,1]
    s_waitcnt lgkmcnt(1)
    v_pk_fma_f32 v[210:211], v[198:199], v[202:203], v[210:211] op_sel:[0,1,0] op_sel_hi:[1,1,1]
    v_cvt_pk_bf16_f32 v210, v210, v211
    s_waitcnt lgkmcnt(0)
    v_pk_mul_f32 v[212:213], v[200:201], v[204:205]
    v_pk_fma_f32 v[212:213], v[202:203], v[206:207], v[212:213]
    v_add_f32 v209, v212, v213
    s_cmp_eq_u32 s10, 0
    s_cbranch_scc1 Lst_17
    buffer_store_dword v210, v7, s[12:15], s57 offen
    s_mov_b64 exec, 1
    buffer_store_dwordx2 v[208:209], v8, s[12:15], s35 offen
    s_mov_b64 exec, -1
    s_branch Lst_18
Lst_17:
    buffer_store_dword v210, v7, s[12:15], s57 offen sc1
    s_mov_b64 exec, 1
    buffer_store_dwordx2 v[208:209], v8, s[12:15], s35 offen sc1
    s_mov_b64 exec, -1
Lst_18:
    s_barrier

    s_waitcnt vmcnt(0) lgkmcnt(0)
    s_barrier
    ds_read_b128 v[192:195], v1 offset:0
    ds_read_b128 v[196:199], v1 offset:64
    ds_read_b128 v[200:203], v1 offset:128
    ds_read_b128 v[204:207], v1 offset:192
    s_mov_b32 s55, 0x3e0293ee
    s_waitcnt lgkmcnt(3)
    v_mfma_f32_16x16x32_bf16 v[208:211], v[64:67], v[192:195], 0
    v_mfma_f32_16x16x32_bf16 v[212:215], v[80:83], v[192:195], 0
    v_mfma_f32_16x16x32_bf16 v[216:219], v[96:99], v[192:195], 0
    v_mfma_f32_16x16x32_bf16 v[220:223], v[112:115], v[192:195], 0
    s_waitcnt lgkmcnt(2)
    v_mfma_f32_16x16x32_bf16 v[208:211], v[68:71], v[196:199], v[208:211]
    v_mfma_f32_16x16x32_bf16 v[212:215], v[84:87], v[196:199], v[212:215]
    v_mfma_f32_16x16x32_bf16 v[216:219], v[100:103], v[196:199], v[216:219]
    v_mfma_f32_16x16x32_bf16 v[220:223], v[116:119], v[196:199], v[220:223]
    s_waitcnt lgkmcnt(1)
    v_mfma_f32_16x16x32_bf16 v[208:211], v[72:75], v[200:203], v[208:211]
    v_mfma_f32_16x16x32_bf16 v[212:215], v[88:91], v[200:203], v[212:215]
    v_mfma_f32_16x16x32_bf16 v[216:219], v[104:107], v[200:203], v[216:219]
    v_mfma_f32_16x16x32_bf16 v[220:223], v[120:123], v[200:203], v[220:223]
    s_waitcnt lgkmcnt(0)
    v_mfma_f32_16x16x32_bf16 v[208:211], v[76:79], v[204:207], v[208:211]
    v_mfma_f32_16x16x32_bf16 v[212:215], v[92:95], v[204:207], v[212:215]
    v_mfma_f32_16x16x32_bf16 v[216:219], v[108:111], v[204:207], v[216:219]
    v_mfma_f32_16x16x32_bf16 v[220:223], v[124:127], v[204:207], v[220:223]
    s_nop 4
    v_max3_f32 v248, v208, v209, v210
    v_max3_f32 v248, v248, v211, v212
    v_max3_f32 v249, v213, v214, v215
    v_max3_f32 v248, v248, v216, v217
    v_max3_f32 v249, v249, v218, v219
    v_max3_f32 v248, v248, v220, v221
    v_max3_f32 v249, v249, v222, v223
    v_max_f32 v248, v248, v249
    v_mov_b32 v249, v248
    v_cndmask_b32 v240, v208, v210, s[36:37]
    v_cndmask_b32 v241, v209, v211, s[36:37]
    v_cndmask_b32 v242, v212, v214, s[36:37]
    v_cndmask_b32 v243, v213, v215, s[36:37]
    v_permlane16_swap_b32 v248, v249
    v_max_f32 v248, v248, v249
    v_mov_b32 v249, v248
    v_cndmask_b32 v244, v216, v218, s[36:37]
    v_cndmask_b32 v245, v217, v219, s[36:37]
    v_cndmask_b32 v246, v220, v222, s[36:37]
    v_cndmask_b32 v247, v221, v223, s[36:37]
    v_permlane32_swap_b32 v248, v249
    v_max_f32 v248, v248, v249
    v_mul_f32 v248, s55, v248
    ds_write_b32 v3, v248
    v_cndmask_b32 v240, v240, v242, s[38:39]
    v_cndmask_b32 v241, v241, v243, s[38:39]
    v_cndmask_b32 v244, v244, v246, s[38:39]
    v_cndmask_b32 v245, v245, v247, s[38:39]
    v_fma_f32 v240, v240, s55, -v248
    v_fma_f32 v241, v241, s55, -v248
    v_fma_f32 v244, v244, s55, -v248
    v_fma_f32 v245, v245, s55, -v248
    v_exp_f32 v240, v240
    v_exp_f32 v241, v241
    v_exp_f32 v244, v244
    v_exp_f32 v245, v245
    s_waitcnt lgkmcnt(0)
    s_barrier
    v_cvt_pk_bf16_f32 v240, v240, v241
    v_cvt_pk_bf16_f32 v244, v244, v245
    s_nop 0
    v_mov_b32_dpp v224, v240 quad_perm:[0,0,0,0] row_mask:0xf bank_mask:0xf
    v_mov_b32_dpp v225, v240 quad_perm:[1,1,1,1] row_mask:0xf bank_mask:0xf
    v_mov_b32_dpp v226, v240 quad_perm:[2,2,2,2] row_mask:0xf bank_mask:0xf
    v_mov_b32_dpp v227, v240 quad_perm:[3,3,3,3] row_mask:0xf bank_mask:0xf
    v_mov_b32_dpp v228, v244 quad_perm:[0,0,0,0] row_mask:0xf bank_mask:0xf
    v_mov_b32_dpp v229, v244 quad_perm:[1,1,1,1] row_mask:0xf bank_mask:0xf
    v_mov_b32_dpp v230, v244 quad_perm:[2,2,2,2] row_mask:0xf bank_mask:0xf
    v_mov_b32_dpp v231, v244 quad_perm:[3,3,3,3] row_mask:0xf bank_mask:0xf
    v_mfma_f32_16x16x32_bf16 v[32:35], v[224:227], v[128:131], 0
    v_mfma_f32_16x16x32_bf16 v[36:39], v[224:227], v[132:135], 0
    v_mfma_f32_16x16x32_bf16 v[40:43], v[224:227], v[136:139], 0
    v_mfma_f32_16x16x32_bf16 v[44:47], v[224:227], v[140:143], 0
    v_mfma_f32_16x16x32_bf16 v[48:51], v[224:227], v[144:147], 0
    v_mfma_f32_16x16x32_bf16 v[52:55], v[224:227], v[148:151], 0
    v_mfma_f32_16x16x32_bf16 v[56:59], v[224:227], v[152:155], 0
    v_mfma_f32_16x16x32_bf16 v[60:63], v[224:227], v[156:159], 0
    v_mfma_f32_16x16x32_bf16 v[236:239], v[224:227], v[232:235], 0
    v_mfma_f32_16x16x32_bf16 v[32:35], v[228:231], v[160:163], v[32:35]
    v_mfma_f32_16x16x32_bf16 v[36:39], v[228:231], v[164:167], v[36:39]
    v_mfma_f32_16x16x32_bf16 v[40:43], v[228:231], v[168:171], v[40:43]
    v_mfma_f32_16x16x32_bf16 v[44:47], v[228:231], v[172:175], v[44:47]
    v_mfma_f32_16x16x32_bf16 v[48:51], v[228:231], v[176:179], v[48:51]
    v_mfma_f32_16x16x32_bf16 v[52:55], v[228:231], v[180:183], v[52:55]
    v_mfma_f32_16x16x32_bf16 v[56:59], v[228:231], v[184:187], v[56:59]
    v_mfma_f32_16x16x32_bf16 v[60:63], v[228:231], v[188:191], v[60:63]
    v_mfma_f32_16x16x32_bf16 v[236:239], v[228:231], v[232:235], v[236:239]
    s_nop 0
    ds_write2_b32 v2, v32, v36 offset0:0 offset1:80
    s_nop 0
    ds_write2_b32 v2, v40, v44 offset0:160 offset1:240
    s_nop 0
    ds_write2_b32 v17, v48, v52 offset0:0 offset1:80
    s_nop 0
    ds_write2_b32 v17, v56, v60 offset0:160 offset1:240
    ds_write_b32 v4, v236
    s_waitcnt lgkmcnt(0)
    s_barrier
    s_barrier

    v_and_b32 v60, 0x3f803f80, v24
    v_and_b32 v61, 0x3f803f80, v25
    v_and_b32 v62, 0x3f803f80, v26
    v_and_b32 v63, 0x3f803f80, v27
    s_add_u32 s52, s48, 0x27000
    buffer_load_dwordx4 v[32:35], v9, s[12:15], s52 offen offset:0 sc1
    buffer_load_dwordx4 v[36:39], v9, s[12:15], s52 offen offset:1024 sc1
    s_add_u32 s52, s48, 0xe800
    s_add_u32 s57, s48, 0x27000
    v_mov_b32 v44, 0x3727c5ac
    s_mov_b32 s53, 0
Lp_19:
    buffer_load_dwordx4 v[40:43], v10, s[12:15], s52 offen offset:0 sc1
    s_waitcnt vmcnt(0)
    v_max3_u32 v28, v40, v41, v42
    v_max_u32 v28, v28, v43
    v_cmp_eq_u32 vcc, -1, v28
    s_cbranch_vccz Lpd_20
    s_add_u32 s53, s53, 1
    s_cmp_lt_u32 s53, s11
    s_cbranch_scc1 Lp_19
    s_mov_b32 s11, 0
Lpd_20:
    buffer_load_dwordx4 v[32:35], v9, s[12:15], s57 offen offset:0 sc1
    buffer_load_dwordx4 v[36:39], v9, s[12:15], s57 offen offset:1024 sc1
    v_add_f32 v40, v40, v42
    v_add_f32 v41, v41, v43
    s_nop 0
    v_add_f32_dpp v40, v40, v40 quad_perm:[1,0,3,2] row_mask:0xf bank_mask:0xf
    v_add_f32_dpp v41, v41, v41 quad_perm:[1,0,3,2] row_mask:0xf bank_mask:0xf
    s_nop 0
    v_add_f32_dpp v40, v40, v40 quad_perm:[2,3,0,1] row_mask:0xf bank_mask:0xf
    v_add_f32_dpp v41, v41, v41 quad_perm:[2,3,0,1] row_mask:0xf bank_mask:0xf
    s_nop 0
    v_add_f32_dpp v40, v40, v40 row_half_mirror row_mask:0xf bank_mask:0xf
    v_add_f32_dpp v41, v41, v41 row_half_mirror row_mask:0xf bank_mask:0xf
    s_nop 0
    v_add_f32_dpp v40, v40, v40 row_mirror row_mask:0xf bank_mask:0xf
    v_add_f32_dpp v41, v41, v41 row_mirror row_mask:0xf bank_mask:0xf
    v_mul_f32 v40, 0x3b000000, v40
    v_fmac_f32 v44, 0x3b000000, v41
    v_fma_f32 v41, -v40, v40, v44
    v_max_f32 v41, 0x3727c5ac, v41
    buffer_load_dwordx4 v[216:219], v9, s[12:15], s57 offen offset:0 sc1
    buffer_load_dwordx4 v[220:223], v9, s[12:15], s57 offen offset:1024 sc1
    v_rsq_f32 v41, v41
    v_mul_f32_e64 v48, -v40, v20
    v_mul_f32_e64 v49, -v40, v21
    v_mul_f32_e64 v50, -v40, v22
    v_mul_f32_e64 v51, -v40, v23
    s_mov_b32 s53, 0
Lq_21:
    s_waitcnt vmcnt(2)
    v_mfma_f32_16x16x32_bf16 v[52:55], v[60:63], v[32:35], v[48:51]
    v_mfma_f32_16x16x32_bf16 v[52:55], v[60:63], v[36:39], v[52:55]
    v_max3_u32 v28, v32, v33, v34
    v_max3_u32 v28, v28, v35, v36
    v_max3_u32 v28, v28, v37, v38
    v_max_u32 v28, v28, v39
    v_cmp_eq_u32 vcc, -1, v28
    s_cbranch_vccz Lqd_22
    buffer_load_dwordx4 v[32:35], v9, s[12:15], s57 offen offset:0 sc1
    buffer_load_dwordx4 v[36:39], v9, s[12:15], s57 offen offset:1024 sc1
    s_waitcnt vmcnt(2)
    v_mfma_f32_16x16x32_bf16 v[52:55], v[60:63], v[216:219], v[48:51]
    v_mfma_f32_16x16x32_bf16 v[52:55], v[60:63], v[220:223], v[52:55]
    v_max3_u32 v28, v216, v217, v218
    v_max3_u32 v28, v28, v219, v220
    v_max3_u32 v28, v28, v221, v222
    v_max_u32 v28, v28, v223
    v_cmp_eq_u32 vcc, -1, v28
    s_cbranch_vccz Lqd_22
    buffer_load_dwordx4 v[216:219], v9, s[12:15], s57 offen offset:0 sc1
    buffer_load_dwordx4 v[220:223], v9, s[12:15], s57 offen offset:1024 sc1
    s_add_u32 s53, s53, 1
    s_cmp_lt_u32 s53, s11
    s_cbranch_scc1 Lq_21
    s_mov_b32 s11, 0
Lqd_22:
    s_nop 1
    v_pk_mul_f32 v[52:53], v[52:53], v[40:41] op_sel:[0,1] op_sel_hi:[1,1]
    v_pk_mul_f32 v[54:55], v[54:55], v[40:41] op_sel:[0,1] op_sel_hi:[1,1]
    v_cvt_pk_bf16_f32 v52, v52, v53
    v_cvt_pk_bf16_f32 v53, v54, v55
    ds_write_b64 v11, v[52:53]
    s_add_u32 s35, s48, 0xd800
    s_add_u32 s57, s48, 0x1b000
    s_waitcnt lgkmcnt(0)
    s_barrier
    s_barrier
    ds_read_b128 v[200:203], v6
    s_waitcnt lgkmcnt(0)
    v_max3_f32 v208, v200, v201, v202
    v_max_f32 v208, v208, v203
    s_cmp_eq_u32 s10, 0
    s_cbranch_scc1 Lst_23
    s_mov_b64 exec, 1
    buffer_store_dword v208, v8, s[12:15], s35 offen
    s_mov_b64 exec, -1
    s_branch Lst_24
Lst_23:
    s_mov_b64 exec, 1
    buffer_store_dword v208, v8, s[12:15], s35 offen sc1
    s_mov_b64 exec, -1
Lst_24:
    v_sub_f32 v200, v200, v208
    v_sub_f32 v201, v201, v208
    v_sub_f32 v202, v202, v208
    v_sub_f32 v203, v203, v208
    v_exp_f32 v200, v200
    v_exp_f32 v201, v201
    v_exp_f32 v202, v202
    v_exp_f32 v203, v203
    s_barrier
    ds_read_b64 v[192:193], v5 offset:0
    ds_read_b64 v[194:195], v5 offset:16384
    ds_read_b64 v[196:197], v5 offset:32768
    ds_read_b64 v[198:199], v5 offset:49152
    ds_read_b128 v[204:207], v6 offset:64
    s_waitcnt lgkmcnt(4)
    v_pk_mul_f32 v[210:211], v[192:193], v[200:201] op_sel:[0,0] op_sel_hi:[1,0]
    s_waitcnt lgkmcnt(3)
    v_pk_fma_f32 v[210:211], v[194:195], v[200:201], v[210:211] op_sel:[0,1,0] op_sel_hi:[1,1,1]
    s_waitcnt lgkmcnt(2)
    v_pk_fma_f32 v[210:211], v[196:197], v[202:203], v[210:211] op_sel:[0,0,0] op_sel_hi:[1,0,1]
    s_waitcnt lgkmcnt(1)
    v_pk_fma_f32 v[210:211], v[198:199], v[202:203], v[210:211] op_sel:[0,1,0] op_sel_hi:[1,1,1]
    v_cvt_pk_bf16_f32 v210, v210, v211
    s_waitcnt lgkmcnt(0)
    v_pk_mul_f32 v[212:213], v[200:201], v[204:205]
    v_pk_fma_f32 v[212:213], v[202:203], v[206:207], v[212:213]
    v_add_f32 v209, v212, v213
    s_cmp_eq_u32 s10, 0
    s_cbranch_scc1 Lst_25
    buffer_store_dword v210, v7, s[12:15], s57 offen
    s_mov_b64 exec, 1
    buffer_store_dwordx2 v[208:209], v8, s[12:15], s35 offen
    s_mov_b64 exec, -1
    s_branch Lst_26
Lst_25:
    buffer_store_dword v210, v7, s[12:15], s57 offen sc1
    s_mov_b64 exec, 1
    buffer_store_dwordx2 v[208:209], v8, s[12:15], s35 offen sc1
    s_mov_b64 exec, -1
Lst_26:
    s_endpgm

L_KB:
    s_barrier
    s_setprio 3
    s_cmp_lg_u32 s7, 4
    s_cbranch_scc1 Low_27
    s_waitcnt lgkmcnt(0)
    s_add_u32 s56, s54, 1
    v_mov_b32 v40, s56
    v_mov_b32 v41, s62

    s_lshl_b32 s55, s4, 8
    s_and_b32 s56, s2, 0xf8
    s_add_u32 s55, s55, s56
    s_add_u32 s55, s55, 0x1b0000
    v_mov_b32 v42, 0
    s_mov_b64 exec, 1
    buffer_store_dwordx2 v[40:41], v42, s[12:15], s55 offen
    s_mov_b64 exec, -1

    s_add_u32 s56, s54, 1
    v_mov_b32 v44, s56
    v_mov_b32 v45, s62
    v_mov_b32 v46, s56
    v_mov_b32 v47, s62

    s_lshl_b32 s55, s4, 12
    s_and_b32 s56, s2, 0xf8
    s_lshl_b32 s56, s56, 4
    s_add_u32 s55, s55, s56
    s_add_u32 s55, s55, 0x1a0000
    v_lshlrev_b32 v48, 4, v0
    s_mov_b64 exec, 0xff
    buffer_store_dwordx4 v[44:47], v48, s[12:15], s55 offen sc1
    s_mov_b64 exec, -1

Low_27:
    v_and_b32 v28, 15, v0
    v_lshrrev_b32 v29, 4, v0

    v_lshrrev_b32 v53, 2, v28
    v_and_b32 v54, 7, v0
    v_lshlrev_b32 v55, 4, v0
    v_lshlrev_b32 v1, 8, v53
    v_lshl_add_u32 v1, v29, 4, v1
    v_add_u32 v1, 131072, v1
    s_lshl_b32 s55, s59, 14
    v_lshlrev_b32 v2, 2, v0
    v_add_u32 v2, s55, v2
    v_add_u32 v17, 1280, v2
    s_lshl_b32 s55, s59, 2
    s_add_u32 s55, s55, 132096
    v_lshlrev_b32 v3, 4, v53
    v_add_u32 v3, s55, v3
    v_lshlrev_b32 v4, 4, v29
    v_add_u32 v4, s55, v4
    v_add_u32 v4, 64, v4
    s_lshl_b32 s55, s59, 4
    s_add_u32 s55, s55, 132096
    v_mov_b32 v6, s55
    s_lshl_b32 s55, s59, 6
    v_lshrrev_b32 v52, 3, v0
    v_mul_u32_u24 v5, 320, v52
    v_lshl_add_u32 v5, v54, 3, v5
    v_add_u32 v5, s55, v5
    s_lshl_b32 s3, s49, 2
    s_add_u32 s3, s3, s59
    s_lshl_b32 s55, s3, 10
    s_lshl_b32 s56, s61, 8
    s_add_u32 s56, s56, s55
    v_lshlrev_b32 v7, 4, v52
    v_and_b32 v52, 3, v0
    v_lshl_add_u32 v7, v52, 2, v7
    v_bfe_u32 v52, v0, 2, 1
    v_lshl_add_u32 v7, v52, 7, v7
    v_add_u32 v7, s56, v7
    s_lshl_b32 s55, s3, 11
    v_add_u32 v9, s55, v55
    s_lshl_b32 s55, s3, 7
    s_lshl_b32 s56, s61, 3
    s_add_u32 s55, s55, s56
    v_mov_b32 v8, s55
    s_mov_b32 s36, 0xaaaaaaaa
    s_mov_b32 s37, 0xaaaaaaaa
    s_mov_b32 s38, 0xcccccccc
    s_mov_b32 s39, 0xcccccccc
    s_lshl_b32 s55, s49, 8
    v_lshlrev_b32 v10, 4, v28
    v_add_u32 v10, s55, v10
    s_lshl_b32 s55, s59, 8
    s_add_u32 s55, s55, 131072
    v_lshlrev_b32 v11, 4, v28
    v_lshl_add_u32 v11, v29, 3, v11
    v_add_u32 v11, s55, v11
    v_lshlrev_b32 v52, 3, v0
    v_add_u32 v52, 136320, v52
    v_cndmask_b32 v11, v11, v52, s[50:51]

    v_and_b32 v55, 1, v28
    v_lshlrev_b32 v55, 4, v55
    v_mov_b32 v52, 0xffff
    v_lshlrev_b32 v52, v55, v52
    v_lshrrev_b32 v55, 1, v28

    v_cmp_eq_u32 vcc, 0, v55
    s_nop 1
    v_cndmask_b32 v24, 0, v52, vcc
    v_cmp_eq_u32 vcc, 1, v55
    s_nop 1
    v_cndmask_b32 v25, 0, v52, vcc
    v_cmp_eq_u32 vcc, 2, v55
    s_nop 1
    v_cndmask_b32 v26, 0, v52, vcc
    v_cmp_eq_u32 vcc, 3, v55
    s_nop 1
    v_cndmask_b32 v27, 0, v52, vcc
    s_setprio 0
    s_branch L_pg2
.p2align 12
L_pg2:
    v_mov_b32 v30, 136192
    s_mov_b32 s53, 0
Lf_28:
    ds_read_b32 v31, v30
    s_waitcnt lgkmcnt(0)
    v_readfirstlane_b32 s55, v31
    s_nop 0
    s_cmp_ge_u32 s55, 4
    s_cbranch_scc1 Lfd_29
    s_add_u32 s53, s53, 1
    s_cmp_lt_u32 s53, 0x200000
    s_cbranch_scc1 Lf_28
Lfd_29:

    s_lshl_b32 s55, s4, 8
    s_add_u32 s55, s55, 0x1b0000
    v_and_b32 v18, 31, v0
    v_lshlrev_b32 v18, 3, v18
    v_add_u32 v18, s55, v18

    buffer_load_dwordx2 v[60:61], v18, s[12:15], 0 offen nt
    s_add_u32 m0, s58, 0
    s_add_u32 s52, s63, 0
    s_and_b32 s52, s52, 0x3c00
    buffer_load_dwordx4 v12, s[24:27], s52 offen nt lds
    s_add_u32 m0, s58, 1024
    s_add_u32 s52, s63, 1024
    s_and_b32 s52, s52, 0x3c00
    buffer_load_dwordx4 v13, s[24:27], s52 offen nt lds
    s_add_u32 m0, s58, 2048
    s_add_u32 s52, s63, 2048
    s_and_b32 s52, s52, 0x3c00
    buffer_load_dwordx4 v14, s[24:27], s52 offen nt lds
    s_add_u32 m0, s58, 3072
    s_add_u32 s52, s63, 3072
    s_and_b32 s52, s52, 0x3c00
    buffer_load_dwordx4 v15, s[24:27], s52 offen nt lds
    s_add_u32 m0, s58, 4096
    s_add_u32 s52, s63, 4096
    s_and_b32 s52, s52, 0x3c00
    buffer_load_dwordx4 v12, s[24:27], s52 offen nt lds
    s_add_u32 m0, s58, 5120
    s_add_u32 s52, s63, 5120
    s_and_b32 s52, s52, 0x3c00
    buffer_load_dwordx4 v13, s[24:27], s52 offen nt lds
    s_add_u32 m0, s58, 6144
    s_add_u32 s52, s63, 6144
    s_and_b32 s52, s52, 0x3c00
    buffer_load_dwordx4 v14, s[24:27], s52 offen nt lds
    s_add_u32 m0, s58, 7168
    s_add_u32 s52, s63, 7168
    s_and_b32 s52, s52, 0x3c00
    buffer_load_dwordx4 v15, s[24:27], s52 offen nt lds
    s_setprio 3
    s_waitcnt vmcnt(8)
    s_add_u32 s55, s54, 1
    v_cmp_ne_u32 vcc, s55, v60
    v_cmp_ne_u32 s[98:99], s62, v61
    s_nop 0
    s_or_b64 vcc, vcc, s[98:99]
    s_mov_b32 s10, 1
    s_cbranch_vccz Lhm_30
    s_add_u32 s56, s54, 1
    s_mov_b32 s53, 0
Lp_34:
    buffer_load_dwordx2 v[60:61], v18, s[12:15], 0 offen sc1
    s_waitcnt vmcnt(0)
    v_cmp_ne_u32 vcc, s56, v60
    s_cbranch_vccz Lpd_35
    s_add_u32 s53, s53, 1
    s_cmp_lt_u32 s53, 64
    s_cbranch_scc1 Lp_34
Lpd_35:
    s_cbranch_vccnz Lhs_32
    v_cmp_ne_u32 vcc, s62, v61
    s_mov_b32 s10, 1
    s_cbranch_vccz Lhs_31
    s_branch Lhs_33
Lhs_32:

    s_lshl_b32 s55, s4, 12
    s_add_u32 s55, s55, 0x1a0000
    v_and_b32 v40, 31, v0
    v_lshlrev_b32 v40, 7, v40
    v_add_u32 v40, s55, v40

    s_mov_b32 s53, 0
Lp_36:
    buffer_load_dwordx2 v[60:61], v40, s[12:15], 0 offen sc1
    s_waitcnt vmcnt(0)
    v_cmp_ne_u32 vcc, s56, v60
    s_cbranch_vccz Lpd_37
    s_add_u32 s53, s53, 1
    s_cmp_lt_u32 s53, s11
    s_cbranch_scc1 Lp_36
    s_mov_b32 s11, 0
Lpd_37:
    v_cmp_ne_u32 vcc, s62, v61
    s_mov_b32 s10, 1
    s_cbranch_vccz Lhs_31
Lhs_33:
    s_mov_b32 s10, 0
    s_add_u32 s48, s48, 0x800000

    s_lshl_b32 s55, s4, 12
    s_add_u32 s55, s55, 0x1a8080
    v_and_b32 v46, 7, v0
    v_lshlrev_b32 v46, 9, v46
    v_add_u32 v46, s55, v46

    s_add_u32 s56, s54, 1
    s_mov_b32 s53, 0
Lp_38:
    buffer_load_dwordx2 v[60:61], v46, s[12:15], 0 offen sc1
    s_waitcnt vmcnt(0)
    v_cmp_ne_u32 vcc, s56, v60
    s_cbranch_vccz Lpd_39
    s_add_u32 s53, s53, 1
    s_cmp_lt_u32 s53, s11
    s_cbranch_scc1 Lp_38
    s_mov_b32 s11, 0
Lpd_39:
Lhs_31:
Lhm_30:
    v_mov_b32 v30, s10
    v_mov_b32 v31, 136260
    ds_write_b32 v31, v30
    s_add_u32 s35, s48, 0xc000
    s_add_u32 s57, s48, 0xf000
    s_waitcnt lgkmcnt(0)
    s_barrier
    s_barrier
    ds_read_b128 v[200:203], v6
    s_waitcnt lgkmcnt(0)
    v_max3_f32 v208, v200, v201, v202
    v_max_f32 v208, v208, v203
    s_cmp_eq_u32 s10, 0
    s_cbranch_scc1 Lst_40
    s_mov_b64 exec, 1
    buffer_store_dword v208, v8, s[12:15], s35 offen
    s_mov_b64 exec, -1
    s_branch Lst_41
Lst_40:
    s_mov_b64 exec, 1
    buffer_store_dword v208, v8, s[12:15], s35 offen sc1
    s_mov_b64 exec, -1
Lst_41:
    v_sub_f32 v200, v200, v208
    v_sub_f32 v201, v201, v208
    v_sub_f32 v202, v202, v208
    v_sub_f32 v203, v203, v208
    v_exp_f32 v200, v200
    v_exp_f32 v201, v201
    v_exp_f32 v202, v202
    v_exp_f32 v203, v203
    s_barrier
    ds_read_b64 v[192:193], v5 offset:0
    ds_read_b64 v[194:195], v5 offset:16384
    ds_read_b64 v[196:197], v5 offset:32768
    ds_read_b64 v[198:199], v5 offset:49152
    ds_read_b128 v[204:207], v6 offset:64
    s_waitcnt lgkmcnt(4)
    v_pk_mul_f32 v[210:211], v[192:193], v[200:201] op_sel:[0,0] op_sel_hi:[1,0]
    s_waitcnt lgkmcnt(3)
    v_pk_fma_f32 v[210:211], v[194:195], v[200:201], v[210:211] op_sel:[0,1,0] op_sel_hi:[1,1,1]
    s_waitcnt lgkmcnt(2)
    v_pk_fma_f32 v[210:211], v[196:197], v[202:203], v[210:211] op_sel:[0,0,0] op_sel_hi:[1,0,1]
    s_waitcnt lgkmcnt(1)
    v_pk_fma_f32 v[210:211], v[198:199], v[202:203], v[210:211] op_sel:[0,1,0] op_sel_hi:[1,1,1]
    v_cvt_pk_bf16_f32 v210, v210, v211
    s_waitcnt lgkmcnt(0)
    v_pk_mul_f32 v[212:213], v[200:201], v[204:205]
    v_pk_fma_f32 v[212:213], v[202:203], v[206:207], v[212:213]
    v_add_f32 v209, v212, v213
    s_cmp_eq_u32 s10, 0
    s_cbranch_scc1 Lst_42
    buffer_store_dword v210, v7, s[12:15], s57 offen
    s_mov_b64 exec, 1
    buffer_store_dwordx2 v[208:209], v8, s[12:15], s35 offen
    s_mov_b64 exec, -1
    s_branch Lst_43
Lst_42:
    buffer_store_dword v210, v7, s[12:15], s57 offen sc1
    s_mov_b64 exec, 1
    buffer_store_dwordx2 v[208:209], v8, s[12:15], s35 offen sc1
    s_mov_b64 exec, -1
Lst_43:
    s_barrier
    s_setprio 0
    s_waitcnt vmcnt(7)
    s_add_u32 s52, s63, 0
    s_and_b32 s52, s52, 0x3c00
    buffer_load_dwordx4 v[192:195], v16, s[28:31], s52 offen nt
    s_waitcnt vmcnt(7)
    s_add_u32 s52, s63, 1024
    s_and_b32 s52, s52, 0x3c00
    buffer_load_dwordx4 v[196:199], v16, s[28:31], s52 offen nt
    s_waitcnt vmcnt(7)
    s_add_u32 m0, s58, 8192
    s_add_u32 s52, s63, 8192
    s_and_b32 s52, s52, 0x3c00
    buffer_load_dwordx4 v12, s[24:27], s52 offen nt lds
    s_waitcnt vmcnt(7)
    s_add_u32 s52, s63, 2048
    s_and_b32 s52, s52, 0x3c00
    buffer_load_dwordx4 v[200:203], v16, s[28:31], s52 offen nt
    s_waitcnt vmcnt(7)
    s_add_u32 s52, s63, 3072
    s_and_b32 s52, s52, 0x3c00
    buffer_load_dwordx4 v[204:207], v16, s[28:31], s52 offen nt
    s_waitcnt vmcnt(7)
    s_add_u32 s52, s63, 4096
    s_and_b32 s52, s52, 0x3c00
    buffer_load_dwordx4 v[208:211], v16, s[28:31], s52 offen nt
    s_waitcnt vmcnt(7)
    s_add_u32 m0, s58, 9216
    s_add_u32 s52, s63, 9216
    s_and_b32 s52, s52, 0x3c00
    buffer_load_dwordx4 v13, s[24:27], s52 offen nt lds
    s_waitcnt vmcnt(7)
    s_add_u32 s52, s63, 5120
    s_and_b32 s52, s52, 0x3c00
    buffer_load_dwordx4 v[212:215], v16, s[28:31], s52 offen nt
    s_waitcnt vmcnt(7)
    s_add_u32 s52, s63, 6144
    s_and_b32 s52, s52, 0x3c00
    buffer_load_dwordx4 v[216:219], v16, s[28:31], s52 offen nt
    s_waitcnt vmcnt(7)
    s_add_u32 s52, s63, 7168
    s_and_b32 s52, s52, 0x3c00
    buffer_load_dwordx4 v[220:223], v16, s[28:31], s52 offen nt
    s_waitcnt vmcnt(7)
    s_add_u32 m0, s58, 10240
    s_add_u32 s52, s63, 10240
    s_and_b32 s52, s52, 0x3c00
    buffer_load_dwordx4 v14, s[24:27], s52 offen nt lds
    s_waitcnt vmcnt(7)
    s_add_u32 s52, s63, 8192
    s_and_b32 s52, s52, 0x3c00
    buffer_load_dwordx4 v[224:227], v16, s[28:31], s52 offen nt

    s_waitcnt vmcnt(7)
    s_add_u32 s52, s63, 9216
    s_and_b32 s52, s52, 0x3c00
    buffer_load_dwordx4 v[228:231], v16, s[28:31], s52 offen nt
    s_waitcnt vmcnt(7)
    s_add_u32 s52, s63, 10240
    s_and_b32 s52, s52, 0x3c00
    buffer_load_dwordx4 v[232:235], v16, s[28:31], s52 offen nt
    s_waitcnt vmcnt(7)
    s_add_u32 m0, s58, 11264
    s_add_u32 s52, s63, 11264
    s_and_b32 s52, s52, 0x3c00
    buffer_load_dwordx4 v15, s[24:27], s52 offen nt lds
    s_waitcnt vmcnt(7)
    s_add_u32 s52, s63, 11264
    s_and_b32 s52, s52, 0x3c00
    buffer_load_dwordx4 v[236:239], v16, s[28:31], s52 offen nt

    s_waitcnt vmcnt(7)
    s_add_u32 m0, s58, 12288
    s_add_u32 s52, s63, 12288
    s_and_b32 s52, s52, 0x3c00
    buffer_load_dwordx4 v12, s[24:27], s52 offen nt lds
    s_waitcnt vmcnt(7)
    s_add_u32 s52, s63, 12288
    s_and_b32 s52, s52, 0x3c00
    buffer_load_dwordx4 v[240:243], v16, s[28:31], s52 offen nt
    s_waitcnt vmcnt(7)
    s_add_u32 m0, s58, 13312
    s_add_u32 s52, s63, 13312
    s_and_b32 s52, s52, 0x3c00
    buffer_load_dwordx4 v13, s[24:27], s52 offen nt lds
    s_waitcnt vmcnt(7)
    s_add_u32 s52, s63, 13312
    s_and_b32 s52, s52, 0x3c00
    buffer_load_dwordx4 v[244:247], v16, s[28:31], s52 offen nt

    s_waitcnt vmcnt(7)
    s_add_u32 m0, s58, 14336
    s_add_u32 s52, s63, 14336
    s_and_b32 s52, s52, 0x3c00
    buffer_load_dwordx4 v14, s[24:27], s52 offen nt lds
    s_waitcnt vmcnt(7)
    s_add_u32 s52, s63, 14336
    s_and_b32 s52, s52, 0x3c00
    buffer_load_dwordx4 v[248:251], v16, s[28:31], s52 offen nt
    s_waitcnt vmcnt(7)
    s_add_u32 m0, s58, 15360
    s_add_u32 s52, s63, 15360
    s_and_b32 s52, s52, 0x3c00
    buffer_load_dwordx4 v15, s[24:27], s52 offen nt lds
    s_waitcnt vmcnt(7)
    s_add_u32 s52, s63, 15360
    s_and_b32 s52, s52, 0x3c00
    buffer_load_dwordx4 v[252:255], v16, s[28:31], s52 offen nt

    v_mov_b32 v30, 136212
    v_mov_b32 v31, 1
    s_mov_b64 exec, 1
    ds_add_u32 v30, v31
    s_mov_b64 exec, -1
    s_setprio 3
    v_and_b32 v28, 15, v0
    v_lshrrev_b32 v29, 4, v0

    v_lshrrev_b32 v30, 2, v28
    v_and_b32 v31, 3, v28
    v_lshl_add_u32 v31, v31, 2, v30
    v_xor_b32 v40, v29, v28
    v_lshlrev_b32 v40, 4, v40
    v_lshl_add_u32 v40, v31, 8, v40
    v_add_u32 v40, s58, v40

    v_xor_b32 v41, 64, v40
    v_xor_b32 v42, 128, v40
    v_xor_b32 v43, 192, v40
    s_waitcnt vmcnt(27)
    ds_read_b128 v[64:67], v40 offset:0
    ds_read_b128 v[68:71], v41 offset:0
    ds_read_b128 v[72:75], v42 offset:0
    ds_read_b128 v[76:79], v43 offset:0
    ds_read_b128 v[80:83], v40 offset:4096
    ds_read_b128 v[84:87], v41 offset:4096
    ds_read_b128 v[88:91], v42 offset:4096
    ds_read_b128 v[92:95], v43 offset:4096
    s_waitcnt vmcnt(22)
    v_perm_b32 v128, v196, v192, s46
    v_perm_b32 v132, v196, v192, s47
    v_perm_b32 v136, v197, v193, s46
    v_perm_b32 v140, v197, v193, s47
    v_perm_b32 v144, v198, v194, s46
    v_perm_b32 v148, v198, v194, s47
    v_perm_b32 v152, v199, v195, s46
    v_perm_b32 v156, v199, v195, s47
    s_waitcnt vmcnt(19)
    v_perm_b32 v129, v204, v200, s46
    v_perm_b32 v133, v204, v200, s47
    v_perm_b32 v137, v205, v201, s46
    v_perm_b32 v141, v205, v201, s47
    v_perm_b32 v145, v206, v202, s46
    v_perm_b32 v149, v206, v202, s47
    v_perm_b32 v153, v207, v203, s46
    v_perm_b32 v157, v207, v203, s47
    s_waitcnt vmcnt(16)
    v_perm_b32 v130, v212, v208, s46
    v_perm_b32 v134, v212, v208, s47
    v_perm_b32 v138, v213, v209, s46
    v_perm_b32 v142, v213, v209, s47
    v_perm_b32 v146, v214, v210, s46
    v_perm_b32 v150, v214, v210, s47
    v_perm_b32 v154, v215, v211, s46
    v_perm_b32 v158, v215, v211, s47
    s_waitcnt vmcnt(14)
    v_perm_b32 v131, v220, v216, s46
    v_perm_b32 v135, v220, v216, s47
    v_perm_b32 v139, v221, v217, s46
    v_perm_b32 v143, v221, v217, s47
    v_perm_b32 v147, v222, v218, s46
    v_perm_b32 v151, v222, v218, s47
    v_perm_b32 v155, v223, v219, s46
    v_perm_b32 v159, v223, v219, s47
    s_waitcnt vmcnt(1)
    ds_read_b128 v[96:99], v40 offset:8192
    ds_read_b128 v[100:103], v41 offset:8192
    ds_read_b128 v[104:107], v42 offset:8192
    ds_read_b128 v[108:111], v43 offset:8192
    ds_read_b128 v[112:115], v40 offset:12288
    ds_read_b128 v[116:119], v41 offset:12288
    ds_read_b128 v[120:123], v42 offset:12288
    ds_read_b128 v[124:127], v43 offset:12288
    s_waitcnt vmcnt(11)
    v_perm_b32 v160, v228, v224, s46
    v_perm_b32 v164, v228, v224, s47
    v_perm_b32 v168, v229, v225, s46
    v_perm_b32 v172, v229, v225, s47
    v_perm_b32 v176, v230, v226, s46
    v_perm_b32 v180, v230, v226, s47
    v_perm_b32 v184, v231, v227, s46
    v_perm_b32 v188, v231, v227, s47
    s_waitcnt vmcnt(8)
    v_perm_b32 v161, v236, v232, s46
    v_perm_b32 v165, v236, v232, s47
    v_perm_b32 v169, v237, v233, s46
    v_perm_b32 v173, v237, v233, s47
    v_perm_b32 v177, v238, v234, s46
    v_perm_b32 v181, v238, v234, s47
    v_perm_b32 v185, v239, v235, s46
    v_perm_b32 v189, v239, v235, s47
    s_waitcnt vmcnt(4)
    v_perm_b32 v162, v244, v240, s46
    v_perm_b32 v166, v244, v240, s47
    v_perm_b32 v170, v245, v241, s46
    v_perm_b32 v174, v245, v241, s47
    v_perm_b32 v178, v246, v242, s46
    v_perm_b32 v182, v246, v242, s47
    v_perm_b32 v186, v247, v243, s46
    v_perm_b32 v190, v247, v243, s47
    s_waitcnt vmcnt(0)
    v_perm_b32 v163, v252, v248, s46
    v_perm_b32 v167, v252, v248, s47
    v_perm_b32 v171, v253, v249, s46
    v_perm_b32 v175, v253, v249, s47
    v_perm_b32 v179, v254, v250, s46
    v_perm_b32 v183, v254, v250, s47
    v_perm_b32 v187, v255, v251, s46
    v_perm_b32 v191, v255, v251, s47
    v_mov_b32 v232, 0x3f803f80
    v_mov_b32 v233, 0x3f803f80
    v_mov_b32 v234, 0x3f803f80
    v_mov_b32 v235, 0x3f803f80
    s_waitcnt vmcnt(0) lgkmcnt(0)
    s_barrier
    ds_read_b128 v[192:195], v1 offset:0
    ds_read_b128 v[196:199], v1 offset:64
    ds_read_b128 v[200:203], v1 offset:128
    ds_read_b128 v[204:207], v1 offset:192
    s_mov_b32 s55, 0x3e0293ee
    s_waitcnt lgkmcnt(3)
    v_mfma_f32_16x16x32_bf16 v[208:211], v[64:67], v[192:195], 0
    v_mfma_f32_16x16x32_bf16 v[212:215], v[80:83], v[192:195], 0
    v_mfma_f32_16x16x32_bf16 v[216:219], v[96:99], v[192:195], 0
    v_mfma_f32_16x16x32_bf16 v[220:223], v[112:115], v[192:195], 0
    s_waitcnt lgkmcnt(2)
    v_mfma_f32_16x16x32_bf16 v[208:211], v[68:71], v[196:199], v[208:211]
    v_mfma_f32_16x16x32_bf16 v[212:215], v[84:87], v[196:199], v[212:215]
    v_mfma_f32_16x16x32_bf16 v[216:219], v[100:103], v[196:199], v[216:219]
    v_mfma_f32_16x16x32_bf16 v[220:223], v[116:119], v[196:199], v[220:223]
    s_waitcnt lgkmcnt(1)
    v_mfma_f32_16x16x32_bf16 v[208:211], v[72:75], v[200:203], v[208:211]
    v_mfma_f32_16x16x32_bf16 v[212:215], v[88:91], v[200:203], v[212:215]
    v_mfma_f32_16x16x32_bf16 v[216:219], v[104:107], v[200:203], v[216:219]
    v_mfma_f32_16x16x32_bf16 v[220:223], v[120:123], v[200:203], v[220:223]
    s_waitcnt lgkmcnt(0)
    v_mfma_f32_16x16x32_bf16 v[208:211], v[76:79], v[204:207], v[208:211]
    v_mfma_f32_16x16x32_bf16 v[212:215], v[92:95], v[204:207], v[212:215]
    v_mfma_f32_16x16x32_bf16 v[216:219], v[108:111], v[204:207], v[216:219]
    v_mfma_f32_16x16x32_bf16 v[220:223], v[124:127], v[204:207], v[220:223]
    s_nop 4
    v_max3_f32 v248, v208, v209, v210
    v_max3_f32 v248, v248, v211, v212
    v_max3_f32 v249, v213, v214, v215
    v_max3_f32 v248, v248, v216, v217
    v_max3_f32 v249, v249, v218, v219
    v_max3_f32 v248, v248, v220, v221
    v_max3_f32 v249, v249, v222, v223
    v_max_f32 v248, v248, v249
    v_mov_b32 v249, v248
    v_cndmask_b32 v240, v208, v210, s[36:37]
    v_cndmask_b32 v241, v209, v211, s[36:37]
    v_cndmask_b32 v242, v212, v214, s[36:37]
    v_cndmask_b32 v243, v213, v215, s[36:37]
    v_permlane16_swap_b32 v248, v249
    v_max_f32 v248, v248, v249
    v_mov_b32 v249, v248
    v_cndmask_b32 v244, v216, v218, s[36:37]
    v_cndmask_b32 v245, v217, v219, s[36:37]
    v_cndmask_b32 v246, v220, v222, s[36:37]
    v_cndmask_b32 v247, v221, v223, s[36:37]
    v_permlane32_swap_b32 v248, v249
    v_max_f32 v248, v248, v249
    v_mul_f32 v248, s55, v248
    ds_write_b32 v3, v248
    v_cndmask_b32 v240, v240, v242, s[38:39]
    v_cndmask_b32 v241, v241, v243, s[38:39]
    v_cndmask_b32 v244, v244, v246, s[38:39]
    v_cndmask_b32 v245, v245, v247, s[38:39]
    v_fma_f32 v240, v240, s55, -v248
    v_fma_f32 v241, v241, s55, -v248
    v_fma_f32 v244, v244, s55, -v248
    v_fma_f32 v245, v245, s55, -v248
    v_exp_f32 v240, v240
    v_exp_f32 v241, v241
    v_exp_f32 v244, v244
    v_exp_f32 v245, v245
    s_waitcnt lgkmcnt(0)
    s_barrier
    v_cvt_pk_bf16_f32 v240, v240, v241
    v_cvt_pk_bf16_f32 v244, v244, v245
    s_nop 0
    v_mov_b32_dpp v224, v240 quad_perm:[0,0,0,0] row_mask:0xf bank_mask:0xf
    v_mov_b32_dpp v225, v240 quad_perm:[1,1,1,1] row_mask:0xf bank_mask:0xf
    v_mov_b32_dpp v226, v240 quad_perm:[2,2,2,2] row_mask:0xf bank_mask:0xf
    v_mov_b32_dpp v227, v240 quad_perm:[3,3,3,3] row_mask:0xf bank_mask:0xf
    v_mov_b32_dpp v228, v244 quad_perm:[0,0,0,0] row_mask:0xf bank_mask:0xf
    v_mov_b32_dpp v229, v244 quad_perm:[1,1,1,1] row_mask:0xf bank_mask:0xf
    v_mov_b32_dpp v230, v244 quad_perm:[2,2,2,2] row_mask:0xf bank_mask:0xf
    v_mov_b32_dpp v231, v244 quad_perm:[3,3,3,3] row_mask:0xf bank_mask:0xf
    v_mfma_f32_16x16x32_bf16 v[32:35], v[224:227], v[128:131], 0
    v_mfma_f32_16x16x32_bf16 v[36:39], v[224:227], v[132:135], 0
    v_mfma_f32_16x16x32_bf16 v[40:43], v[224:227], v[136:139], 0
    v_mfma_f32_16x16x32_bf16 v[44:47], v[224:227], v[140:143], 0
    v_mfma_f32_16x16x32_bf16 v[48:51], v[224:227], v[144:147], 0
    v_mfma_f32_16x16x32_bf16 v[52:55], v[224:227], v[148:151], 0
    v_mfma_f32_16x16x32_bf16 v[56:59], v[224:227], v[152:155], 0
    v_mfma_f32_16x16x32_bf16 v[60:63], v[224:227], v[156:159], 0
    v_mfma_f32_16x16x32_bf16 v[236:239], v[224:227], v[232:235], 0
    v_mfma_f32_16x16x32_bf16 v[32:35], v[228:231], v[160:163], v[32:35]
    v_mfma_f32_16x16x32_bf16 v[36:39], v[228:231], v[164:167], v[36:39]
    v_mfma_f32_16x16x32_bf16 v[40:43], v[228:231], v[168:171], v[40:43]
    v_mfma_f32_16x16x32_bf16 v[44:47], v[228:231], v[172:175], v[44:47]
    v_mfma_f32_16x16x32_bf16 v[48:51], v[228:231], v[176:179], v[48:51]
    v_mfma_f32_16x16x32_bf16 v[52:55], v[228:231], v[180:183], v[52:55]
    v_mfma_f32_16x16x32_bf16 v[56:59], v[228:231], v[184:187], v[56:59]
    v_mfma_f32_16x16x32_bf16 v[60:63], v[228:231], v[188:191], v[60:63]
    v_mfma_f32_16x16x32_bf16 v[236:239], v[228:231], v[232:235], v[236:239]
    s_nop 0
    ds_write2_b32 v2, v32, v36 offset0:0 offset1:80
    s_nop 0
    ds_write2_b32 v2, v40, v44 offset0:160 offset1:240
    s_nop 0
    ds_write2_b32 v17, v48, v52 offset0:0 offset1:80
    s_nop 0
    ds_write2_b32 v17, v56, v60 offset0:160 offset1:240
    ds_write_b32 v4, v236
    s_waitcnt lgkmcnt(0)
    s_barrier
    s_barrier
    s_branch L_pg3
.p2align 12
L_pg3:
    v_and_b32 v60, 0x3f803f80, v24
    v_and_b32 v61, 0x3f803f80, v25
    v_and_b32 v62, 0x3f803f80, v26
    v_and_b32 v63, 0x3f803f80, v27
    s_add_u32 s52, s48, 0x1f000
    buffer_load_dwordx4 v[32:35], v9, s[12:15], s52 offen offset:0 sc1
    buffer_load_dwordx4 v[36:39], v9, s[12:15], s52 offen offset:1024 sc1
    s_lshl_b32 s55, s49, 13
    s_add_u32 s32, s48, 0x8000
    s_sub_u32 s32, s32, s55
    s_mov_b32 s53, 0
Lp_44:
    buffer_load_dwordx4 v[192:195], v9, s[12:15], s32 offen offset:0 sc1
    buffer_load_dwordx4 v[196:199], v9, s[12:15], s32 offen offset:1024 sc1
    s_waitcnt vmcnt(0)
    v_max3_u32 v28, v192, v193, v194
    v_max3_u32 v28, v28, v195, v196
    v_max3_u32 v28, v28, v197, v198
    v_max_u32 v28, v28, v199
    v_cmp_eq_u32 vcc, -1, v28
    s_cbranch_vccz Lpd_45
    s_add_u32 s53, s53, 1
    s_cmp_lt_u32 s53, s11
    s_cbranch_scc1 Lp_44
    s_mov_b32 s11, 0
Lpd_45:
    v_mfma_f32_16x16x32_bf16 v[20:23], v[60:63], v[192:195], 0
    v_mfma_f32_16x16x32_bf16 v[20:23], v[60:63], v[196:199], v[20:23]
    s_add_u32 s52, s48, 0xe400
    s_add_u32 s57, s48, 0x1f000
    v_mov_b32 v44, 0x3727c5ac
    s_mov_b32 s53, 0
Lp_46:
    buffer_load_dwordx4 v[40:43], v10, s[12:15], s52 offen offset:0 sc1
    s_waitcnt vmcnt(0)
    v_max3_u32 v28, v40, v41, v42
    v_max_u32 v28, v28, v43
    v_cmp_eq_u32 vcc, -1, v28
    s_cbranch_vccz Lpd_47
    s_add_u32 s53, s53, 1
    s_cmp_lt_u32 s53, s11
    s_cbranch_scc1 Lp_46
    s_mov_b32 s11, 0
Lpd_47:
    buffer_load_dwordx4 v[32:35], v9, s[12:15], s57 offen offset:0 sc1
    buffer_load_dwordx4 v[36:39], v9, s[12:15], s57 offen offset:1024 sc1
    v_add_f32 v40, v40, v42
    v_add_f32 v41, v41, v43
    s_nop 0
    v_add_f32_dpp v40, v40, v40 quad_perm:[1,0,3,2] row_mask:0xf bank_mask:0xf
    v_add_f32_dpp v41, v41, v41 quad_perm:[1,0,3,2] row_mask:0xf bank_mask:0xf
    s_nop 0
    v_add_f32_dpp v40, v40, v40 quad_perm:[2,3,0,1] row_mask:0xf bank_mask:0xf
    v_add_f32_dpp v41, v41, v41 quad_perm:[2,3,0,1] row_mask:0xf bank_mask:0xf
    s_nop 0
    v_add_f32_dpp v40, v40, v40 row_half_mirror row_mask:0xf bank_mask:0xf
    v_add_f32_dpp v41, v41, v41 row_half_mirror row_mask:0xf bank_mask:0xf
    s_nop 0
    v_add_f32_dpp v40, v40, v40 row_mirror row_mask:0xf bank_mask:0xf
    v_add_f32_dpp v41, v41, v41 row_mirror row_mask:0xf bank_mask:0xf
    v_mul_f32 v40, 0x3b000000, v40
    v_fmac_f32 v44, 0x3b000000, v41
    v_fma_f32 v41, -v40, v40, v44
    v_max_f32 v41, 0x3727c5ac, v41
    buffer_load_dwordx4 v[216:219], v9, s[12:15], s57 offen offset:0 sc1
    buffer_load_dwordx4 v[220:223], v9, s[12:15], s57 offen offset:1024 sc1
    v_rsq_f32 v41, v41
    v_mul_f32_e64 v48, -v40, v20
    v_mul_f32_e64 v49, -v40, v21
    v_mul_f32_e64 v50, -v40, v22
    v_mul_f32_e64 v51, -v40, v23
    s_mov_b32 s53, 0
Lq_48:
    s_waitcnt vmcnt(2)
    v_mfma_f32_16x16x32_bf16 v[52:55], v[60:63], v[32:35], v[48:51]
    v_mfma_f32_16x16x32_bf16 v[52:55], v[60:63], v[36:39], v[52:55]
    v_max3_u32 v28, v32, v33, v34
    v_max3_u32 v28, v28, v35, v36
    v_max3_u32 v28, v28, v37, v38
    v_max_u32 v28, v28, v39
    v_cmp_eq_u32 vcc, -1, v28
    s_cbranch_vccz Lqd_49
    buffer_load_dwordx4 v[32:35], v9, s[12:15], s57 offen offset:0 sc1
    buffer_load_dwordx4 v[36:39], v9, s[12:15], s57 offen offset:1024 sc1
    s_waitcnt vmcnt(2)
    v_mfma_f32_16x16x32_bf16 v[52:55], v[60:63], v[216:219], v[48:51]
    v_mfma_f32_16x16x32_bf16 v[52:55], v[60:63], v[220:223], v[52:55]
    v_max3_u32 v28, v216, v217, v218
    v_max3_u32 v28, v28, v219, v220
    v_max3_u32 v28, v28, v221, v222
    v_max_u32 v28, v28, v223
    v_cmp_eq_u32 vcc, -1, v28
    s_cbranch_vccz Lqd_49
    buffer_load_dwordx4 v[216:219], v9, s[12:15], s57 offen offset:0 sc1
    buffer_load_dwordx4 v[220:223], v9, s[12:15], s57 offen offset:1024 sc1
    s_add_u32 s53, s53, 1
    s_cmp_lt_u32 s53, s11
    s_cbranch_scc1 Lq_48
    s_mov_b32 s11, 0
Lqd_49:
    s_nop 1
    v_pk_mul_f32 v[52:53], v[52:53], v[40:41] op_sel:[0,1] op_sel_hi:[1,1]
    v_pk_mul_f32 v[54:55], v[54:55], v[40:41] op_sel:[0,1] op_sel_hi:[1,1]
    v_cvt_pk_bf16_f32 v52, v52, v53
    v_cvt_pk_bf16_f32 v53, v54, v55
    ds_write_b64 v11, v[52:53]
    s_add_u32 s35, s48, 0xd000
    s_add_u32 s57, s48, 0x17000
    s_waitcnt lgkmcnt(0)
    s_barrier
    s_barrier
    ds_read_b128 v[200:203], v6
    s_waitcnt lgkmcnt(0)
    v_max3_f32 v208, v200, v201, v202
    v_max_f32 v208, v208, v203
    s_cmp_eq_u32 s10, 0
    s_cbranch_scc1 Lst_50
    s_mov_b64 exec, 1
    buffer_store_dword v208, v8, s[12:15], s35 offen
    s_mov_b64 exec, -1
    s_branch Lst_51
Lst_50:
    s_mov_b64 exec, 1
    buffer_store_dword v208, v8, s[12:15], s35 offen sc1
    s_mov_b64 exec, -1
Lst_51:
    v_sub_f32 v200, v200, v208
    v_sub_f32 v201, v201, v208
    v_sub_f32 v202, v202, v208
    v_sub_f32 v203, v203, v208
    v_exp_f32 v200, v200
    v_exp_f32 v201, v201
    v_exp_f32 v202, v202
    v_exp_f32 v203, v203
    s_barrier
    ds_read_b64 v[192:193], v5 offset:0
    ds_read_b64 v[194:195], v5 offset:16384
    ds_read_b64 v[196:197], v5 offset:32768
    ds_read_b64 v[198:199], v5 offset:49152
    ds_read_b128 v[204:207], v6 offset:64
    s_waitcnt lgkmcnt(4)
    v_pk_mul_f32 v[210:211], v[192:193], v[200:201] op_sel:[0,0] op_sel_hi:[1,0]
    s_waitcnt lgkmcnt(3)
    v_pk_fma_f32 v[210:211], v[194:195], v[200:201], v[210:211] op_sel:[0,1,0] op_sel_hi:[1,1,1]
    s_waitcnt lgkmcnt(2)
    v_pk_fma_f32 v[210:211], v[196:197], v[202:203], v[210:211] op_sel:[0,0,0] op_sel_hi:[1,0,1]
    s_waitcnt lgkmcnt(1)
    v_pk_fma_f32 v[210:211], v[198:199], v[202:203], v[210:211] op_sel:[0,1,0] op_sel_hi:[1,1,1]
    v_cvt_pk_bf16_f32 v210, v210, v211
    s_waitcnt lgkmcnt(0)
    v_pk_mul_f32 v[212:213], v[200:201], v[204:205]
    v_pk_fma_f32 v[212:213], v[202:203], v[206:207], v[212:213]
    v_add_f32 v209, v212, v213
    s_cmp_eq_u32 s10, 0
    s_cbranch_scc1 Lst_52
    buffer_store_dword v210, v7, s[12:15], s57 offen
    s_mov_b64 exec, 1
    buffer_store_dwordx2 v[208:209], v8, s[12:15], s35 offen
    s_mov_b64 exec, -1
    s_branch Lst_53
Lst_52:
    buffer_store_dword v210, v7, s[12:15], s57 offen sc1
    s_mov_b64 exec, 1
    buffer_store_dwordx2 v[208:209], v8, s[12:15], s35 offen sc1
    s_mov_b64 exec, -1
Lst_53:
    s_barrier

    s_waitcnt vmcnt(0) lgkmcnt(0)
    s_barrier
    ds_read_b128 v[192:195], v1 offset:0
    ds_read_b128 v[196:199], v1 offset:64
    ds_read_b128 v[200:203], v1 offset:128
    ds_read_b128 v[204:207], v1 offset:192
    s_mov_b32 s55, 0x3e0293ee
    s_waitcnt lgkmcnt(3)
    v_mfma_f32_16x16x32_bf16 v[208:211], v[64:67], v[192:195], 0
    v_mfma_f32_16x16x32_bf16 v[212:215], v[80:83], v[192:195], 0
    v_mfma_f32_16x16x32_bf16 v[216:219], v[96:99], v[192:195], 0
    v_mfma_f32_16x16x32_bf16 v[220:223], v[112:115], v[192:195], 0
    s_waitcnt lgkmcnt(2)
    v_mfma_f32_16x16x32_bf16 v[208:211], v[68:71], v[196:199], v[208:211]
    v_mfma_f32_16x16x32_bf16 v[212:215], v[84:87], v[196:199], v[212:215]
    v_mfma_f32_16x16x32_bf16 v[216:219], v[100:103], v[196:199], v[216:219]
    v_mfma_f32_16x16x32_bf16 v[220:223], v[116:119], v[196:199], v[220:223]
    s_waitcnt lgkmcnt(1)
    v_mfma_f32_16x16x32_bf16 v[208:211], v[72:75], v[200:203], v[208:211]
    v_mfma_f32_16x16x32_bf16 v[212:215], v[88:91], v[200:203], v[212:215]
    v_mfma_f32_16x16x32_bf16 v[216:219], v[104:107], v[200:203], v[216:219]
    v_mfma_f32_16x16x32_bf16 v[220:223], v[120:123], v[200:203], v[220:223]
    s_waitcnt lgkmcnt(0)
    v_mfma_f32_16x16x32_bf16 v[208:211], v[76:79], v[204:207], v[208:211]
    v_mfma_f32_16x16x32_bf16 v[212:215], v[92:95], v[204:207], v[212:215]
    v_mfma_f32_16x16x32_bf16 v[216:219], v[108:111], v[204:207], v[216:219]
    v_mfma_f32_16x16x32_bf16 v[220:223], v[124:127], v[204:207], v[220:223]
    s_nop 4
    v_max3_f32 v248, v208, v209, v210
    v_max3_f32 v248, v248, v211, v212
    v_max3_f32 v249, v213, v214, v215
    v_max3_f32 v248, v248, v216, v217
    v_max3_f32 v249, v249, v218, v219
    v_max3_f32 v248, v248, v220, v221
    v_max3_f32 v249, v249, v222, v223
    v_max_f32 v248, v248, v249
    v_mov_b32 v249, v248
    v_cndmask_b32 v240, v208, v210, s[36:37]
    v_cndmask_b32 v241, v209, v211, s[36:37]
    v_cndmask_b32 v242, v212, v214, s[36:37]
    v_cndmask_b32 v243, v213, v215, s[36:37]
    v_permlane16_swap_b32 v248, v249
    v_max_f32 v248, v248, v249
    v_mov_b32 v249, v248
    v_cndmask_b32 v244, v216, v218, s[36:37]
    v_cndmask_b32 v245, v217, v219, s[36:37]
    v_cndmask_b32 v246, v220, v222, s[36:37]
    v_cndmask_b32 v247, v221, v223, s[36:37]
    v_permlane32_swap_b32 v248, v249
    v_max_f32 v248, v248, v249
    v_mul_f32 v248, s55, v248
    ds_write_b32 v3, v248
    v_cndmask_b32 v240, v240, v242, s[38:39]
    v_cndmask_b32 v241, v241, v243, s[38:39]
    v_cndmask_b32 v244, v244, v246, s[38:39]
    v_cndmask_b32 v245, v245, v247, s[38:39]
    v_fma_f32 v240, v240, s55, -v248
    v_fma_f32 v241, v241, s55, -v248
    v_fma_f32 v244, v244, s55, -v248
    v_fma_f32 v245, v245, s55, -v248
    v_exp_f32 v240, v240
    v_exp_f32 v241, v241
    v_exp_f32 v244, v244
    v_exp_f32 v245, v245
    s_waitcnt lgkmcnt(0)
    s_barrier
    v_cvt_pk_bf16_f32 v240, v240, v241
    v_cvt_pk_bf16_f32 v244, v244, v245
    s_nop 0
    v_mov_b32_dpp v224, v240 quad_perm:[0,0,0,0] row_mask:0xf bank_mask:0xf
    v_mov_b32_dpp v225, v240 quad_perm:[1,1,1,1] row_mask:0xf bank_mask:0xf
    v_mov_b32_dpp v226, v240 quad_perm:[2,2,2,2] row_mask:0xf bank_mask:0xf
    v_mov_b32_dpp v227, v240 quad_perm:[3,3,3,3] row_mask:0xf bank_mask:0xf
    v_mov_b32_dpp v228, v244 quad_perm:[0,0,0,0] row_mask:0xf bank_mask:0xf
    v_mov_b32_dpp v229, v244 quad_perm:[1,1,1,1] row_mask:0xf bank_mask:0xf
    v_mov_b32_dpp v230, v244 quad_perm:[2,2,2,2] row_mask:0xf bank_mask:0xf
    v_mov_b32_dpp v231, v244 quad_perm:[3,3,3,3] row_mask:0xf bank_mask:0xf
    v_mfma_f32_16x16x32_bf16 v[32:35], v[224:227], v[128:131], 0
    v_mfma_f32_16x16x32_bf16 v[36:39], v[224:227], v[132:135], 0
    v_mfma_f32_16x16x32_bf16 v[40:43], v[224:227], v[136:139], 0
    v_mfma_f32_16x16x32_bf16 v[44:47], v[224:227], v[140:143], 0
    v_mfma_f32_16x16x32_bf16 v[48:51], v[224:227], v[144:147], 0
    v_mfma_f32_16x16x32_bf16 v[52:55], v[224:227], v[148:151], 0
    v_mfma_f32_16x16x32_bf16 v[56:59], v[224:227], v[152:155], 0
    v_mfma_f32_16x16x32_bf16 v[60:63], v[224:227], v[156:159], 0
    v_mfma_f32_16x16x32_bf16 v[236:239], v[224:227], v[232:235], 0
    v_mfma_f32_16x16x32_bf16 v[32:35], v[228:231], v[160:163], v[32:35]
    v_mfma_f32_16x16x32_bf16 v[36:39], v[228:231], v[164:167], v[36:39]
    v_mfma_f32_16x16x32_bf16 v[40:43], v[228:231], v[168:171], v[40:43]
    v_mfma_f32_16x16x32_bf16 v[44:47], v[228:231], v[172:175], v[44:47]
    v_mfma_f32_16x16x32_bf16 v[48:51], v[228:231], v[176:179], v[48:51]
    v_mfma_f32_16x16x32_bf16 v[52:55], v[228:231], v[180:183], v[52:55]
    v_mfma_f32_16x16x32_bf16 v[56:59], v[228:231], v[184:187], v[56:59]
    v_mfma_f32_16x16x32_bf16 v[60:63], v[228:231], v[188:191], v[60:63]
    v_mfma_f32_16x16x32_bf16 v[236:239], v[228:231], v[232:235], v[236:239]
    s_nop 0
    ds_write2_b32 v2, v32, v36 offset0:0 offset1:80
    s_nop 0
    ds_write2_b32 v2, v40, v44 offset0:160 offset1:240
    s_nop 0
    ds_write2_b32 v17, v48, v52 offset0:0 offset1:80
    s_nop 0
    ds_write2_b32 v17, v56, v60 offset0:160 offset1:240
    ds_write_b32 v4, v236
    s_waitcnt lgkmcnt(0)
    s_barrier
    s_endpgm

L_O:

    v_mov_b32 v9, 0
    v_mov_b32 v192, -1
    v_mov_b32 v193, -1
    v_mov_b32 v194, -1
    v_mov_b32 v195, -1
    s_lshl_b32 s55, s59, 13
    s_lshr_b32 s56, s5, 2
    s_lshl_b32 s56, s56, 15
    s_add_u32 s55, s55, s56
    s_lshl_b32 s56, s4, 8
    s_add_u32 s55, s55, s56
    s_bfe_u32 s56, s5, 0x10001
    s_lshl_b32 s56, s56, 7
    s_add_u32 s55, s55, s56
    s_add_u32 s55, s55, 0x100000
    v_and_b32 v196, 7, v0
    v_lshlrev_b32 v196, 4, v196
    v_bfe_u32 v197, v0, 3, 2
    v_lshl_add_u32 v196, v197, 11, v196
    v_lshrrev_b32 v197, 5, v0
    v_lshl_add_u32 v196, v197, 17, v196
    v_mov_b32 v30, 0
    v_mov_b32 v31, 136192
    ds_write_b32 v31, v30
    s_waitcnt lgkmcnt(0)
    s_barrier
    buffer_store_dwordx4 v[192:195], v196, s[12:15], s55 offen sc1
    s_mul_i32 s55, s5, 5888
    s_mul_i32 s3, s59, 2944
    s_add_u32 s55, s55, s3
    s_add_u32 s55, s55, s48

    s_mov_b32 s57, s55
    v_lshlrev_b32 v30, 7, v0
    s_mov_b64 exec, 0x7fffff
    buffer_load_dword v12, v30, s[12:15], s57 offen nt
    s_mov_b64 exec, -1

    v_bfe_u32 v30, v0, 2, 1
    v_lshlrev_b32 v30, 12, v30
    v_and_b32 v31, 3, v0
    v_lshl_add_u32 v30, v31, 7, v30
    s_lshr_b32 s55, s5, 1
    s_lshl_b32 s55, s55, 9
    s_lshl_b32 s56, s59, 14
    s_add_u32 s55, s55, s56
    s_add_u32 s55, s55, s48
    s_add_u32 s55, s55, 0x50000
    s_mov_b64 exec, 0xff
    buffer_load_dword v13, v30, s[12:15], s55 offen nt
    s_mov_b64 exec, -1

    s_waitcnt vmcnt(3)
    s_waitcnt lgkmcnt(0)
    v_lshlrev_b32 v32, 16, v204
    v_and_b32 v33, 0xffff0000, v204
    v_lshlrev_b32 v34, 16, v205
    v_and_b32 v35, 0xffff0000, v205
    v_lshlrev_b32 v36, 16, v206
    v_and_b32 v37, 0xffff0000, v206
    v_lshlrev_b32 v38, 16, v207
    v_and_b32 v39, 0xffff0000, v207
    v_add_f32 v212, v32, v33
    v_add_f32 v212, v212, v34
    v_add_f32 v212, v212, v35
    v_add_f32 v212, v212, v36
    v_add_f32 v212, v212, v37
    v_add_f32 v212, v212, v38
    v_add_f32 v212, v212, v39
    s_nop 1
    v_add_f32_dpp v212, v212, v212 quad_perm:[1,0,3,2] row_mask:0xf bank_mask:0xf
    s_nop 1
    v_add_f32_dpp v212, v212, v212 quad_perm:[2,3,0,1] row_mask:0xf bank_mask:0xf
    s_nop 1
    v_add_f32_dpp v212, v212, v212 row_half_mirror row_mask:0xf bank_mask:0xf
    s_nop 1
    v_add_f32_dpp v212, v212, v212 row_mirror row_mask:0xf bank_mask:0xf
    v_mov_b32 v214, v212
    s_nop 1
    v_permlane16_swap_b32 v212, v214
    v_add_f32 v212, v212, v214
    v_mov_b32 v214, v212
    s_nop 1
    v_permlane32_swap_b32 v212, v214
    v_add_f32 v212, v212, v214
    v_mul_f32 v212, 0x3b000000, v212
    v_sub_f32 v32, v32, v212
    v_sub_f32 v33, v33, v212
    v_sub_f32 v34, v34, v212
    v_sub_f32 v35, v35, v212
    v_sub_f32 v36, v36, v212
    v_sub_f32 v37, v37, v212
    v_sub_f32 v38, v38, v212
    v_sub_f32 v39, v39, v212
    v_mul_f32 v213, v32, v32
    v_fmac_f32 v213, v33, v33
    v_fmac_f32 v213, v34, v34
    v_fmac_f32 v213, v35, v35
    v_fmac_f32 v213, v36, v36
    v_fmac_f32 v213, v37, v37
    v_fmac_f32 v213, v38, v38
    v_fmac_f32 v213, v39, v39
    s_nop 1
    v_add_f32_dpp v213, v213, v213 quad_perm:[1,0,3,2] row_mask:0xf bank_mask:0xf
    s_nop 1
    v_add_f32_dpp v213, v213, v213 quad_perm:[2,3,0,1] row_mask:0xf bank_mask:0xf
    s_nop 1
    v_add_f32_dpp v213, v213, v213 row_half_mirror row_mask:0xf bank_mask:0xf
    s_nop 1
    v_add_f32_dpp v213, v213, v213 row_mirror row_mask:0xf bank_mask:0xf
    v_mov_b32 v214, v213
    s_nop 1
    v_permlane16_swap_b32 v213, v214
    v_add_f32 v213, v213, v214
    v_mov_b32 v214, v213
    s_nop 1
    v_permlane32_swap_b32 v213, v214
    v_add_f32 v213, v213, v214
    v_mul_f32 v213, 0x3b000000, v213
    v_cvt_pk_bf16_f32 v214, v212, v212
    v_lshlrev_b32 v212, 16, v214
    v_cvt_pk_bf16_f32 v214, v213, v213
    v_lshlrev_b32 v213, 16, v214
    v_add_f32 v213, 0x3727c5ac, v213
    v_cvt_pk_bf16_f32 v214, v213, v213
    v_lshlrev_b32 v213, 16, v214
    v_sqrt_f32 v213, v213
    s_nop 0
    v_cvt_pk_bf16_f32 v214, v213, v213
    v_lshlrev_b32 v213, 16, v214
    v_rcp_f32 v213, v213
    s_mul_i32 s55, s59, 192
    s_add_u32 s55, s55, 135424
    v_lshlrev_b32 v210, 1, v0
    v_add_u32 v210, s55, v210
    v_lshlrev_b32 v209, 16, v208
    v_sub_f32 v209, v209, v212
    v_cvt_pk_bf16_f32 v214, v209, v209
    v_lshlrev_b32 v209, 16, v214
    v_mul_f32 v209, v209, v213
    v_cvt_pk_bf16_f32 v209, v209, v209
    ds_write_b16 v210, v209
    s_waitcnt lgkmcnt(0)
    s_barrier
    s_waitcnt vmcnt(1)
    buffer_store_dwordx4 v[192:195], v200, s[12:15], s57 offen offset:0
    buffer_store_dwordx4 v[192:195], v200, s[12:15], s57 offen offset:1024
    buffer_store_dwordx4 v[192:195], v200, s[12:15], s57 offen offset:1920
    s_waitcnt vmcnt(0)
    v_mov_b32 v30, 136192
    v_mov_b32 v31, 1
    s_mov_b64 exec, 1
    ds_add_u32 v30, v31
    s_mov_b64 exec, -1
    s_cmp_lg_u32 s7, 0
    s_cbranch_scc1 Low_54
    v_mov_b32 v30, 136192
    s_mov_b32 s53, 0
Lf_55:
    ds_read_b32 v31, v30
    s_waitcnt lgkmcnt(0)
    v_readfirstlane_b32 s55, v31
    s_nop 0
    s_cmp_ge_u32 s55, 4
    s_cbranch_scc1 Lfd_56
    s_add_u32 s53, s53, 1
    s_cmp_lt_u32 s53, 0x200000
    s_cbranch_scc1 Lf_55
Lfd_56:
    s_add_u32 s56, s54, 1
    v_mov_b32 v196, s56
    v_mov_b32 v197, s62

    s_lshl_b32 s55, s4, 8
    s_and_b32 s56, s2, 0xf8
    s_add_u32 s55, s55, s56
    s_add_u32 s55, s55, 0x1b0000
    v_mov_b32 v198, 0
    s_mov_b64 exec, 1
    buffer_store_dwordx2 v[196:197], v198, s[12:15], s55 offen
    s_mov_b64 exec, -1

    s_add_u32 s56, s54, 1
    v_mov_b32 v216, s56
    v_mov_b32 v217, s62
    v_mov_b32 v218, s56
    v_mov_b32 v219, s62

    s_lshl_b32 s55, s4, 12
    s_and_b32 s56, s2, 0xf8
    s_lshl_b32 s56, s56, 4
    s_add_u32 s55, s55, s56
    s_add_u32 s55, s55, 0x1a0000
    v_lshlrev_b32 v220, 4, v0
    s_mov_b64 exec, 0xff
    buffer_store_dwordx4 v[216:219], v220, s[12:15], s55 offen sc1
    s_mov_b64 exec, -1

Low_54:
    s_barrier
    s_branch L_OJ

L_OG:
    s_mov_b32 s39, 36864
    s_barrier
    v_and_b32 v28, 15, v0
    v_lshrrev_b32 v29, 4, v0

    v_lshrrev_b32 v201, 2, v28
    v_and_b32 v202, 7, v0
    v_lshlrev_b32 v203, 4, v0
    v_mul_u32_u24 v1, 192, v201
    v_lshl_add_u32 v1, v29, 4, v1
    v_add_u32 v1, 135424, v1
    s_lshl_b32 s55, s9, 12
    s_lshr_b32 s56, s59, 1
    s_lshl_b32 s56, s56, 11
    s_add_u32 s55, s55, s56
    s_and_b32 s56, s59, 1
    s_lshl_b32 s56, s56, 7
    s_add_u32 s55, s55, s56
    s_lshl_b32 s56, s6, 8
    s_add_u32 s55, s55, s56
    v_lshlrev_b32 v2, 13, v29
    v_lshl_add_u32 v2, v28, 3, v2
    v_add_u32 v2, s55, v2

    v_and_b32 v30, 31, v0
    v_lshrrev_b32 v31, 3, v30
    v_xor_b32 v31, v31, v30
    v_lshrrev_b32 v29, 5, v0
    v_xor_b32 v31, v31, v29
    s_lshl_b32 s55, s59, 1
    v_xor_b32 v31, s55, v31
    v_and_b32 v31, 7, v31
    v_mul_u32_u24 v30, 1152, v30
    v_lshl_add_u32 v30, v31, 4, v30
    v_add_u32 v30, s39, v30

    s_waitcnt vmcnt(6)
    v_perm_b32 v160, v228, v224, s46
    v_perm_b32 v164, v228, v224, s47
    v_perm_b32 v168, v229, v225, s46
    v_perm_b32 v172, v229, v225, s47
    v_perm_b32 v176, v230, v226, s46
    v_perm_b32 v180, v230, v226, s47
    v_perm_b32 v184, v231, v227, s46
    v_perm_b32 v188, v231, v227, s47
    s_waitcnt vmcnt(4)
    v_perm_b32 v161, v236, v232, s46
    v_perm_b32 v165, v236, v232, s47
    v_perm_b32 v169, v237, v233, s46
    v_perm_b32 v173, v237, v233, s47
    v_perm_b32 v177, v238, v234, s46
    v_perm_b32 v181, v238, v234, s47
    v_perm_b32 v185, v239, v235, s46
    v_perm_b32 v189, v239, v235, s47
    s_waitcnt vmcnt(2)
    v_perm_b32 v162, v244, v240, s46
    v_perm_b32 v166, v244, v240, s47
    v_perm_b32 v170, v245, v241, s46
    v_perm_b32 v174, v245, v241, s47
    v_perm_b32 v178, v246, v242, s46
    v_perm_b32 v182, v246, v242, s47
    v_perm_b32 v186, v247, v243, s46
    v_perm_b32 v190, v247, v243, s47
    s_waitcnt vmcnt(0)
    v_perm_b32 v163, v252, v248, s46
    v_perm_b32 v167, v252, v248, s47
    v_perm_b32 v171, v253, v249, s46
    v_perm_b32 v175, v253, v249, s47
    v_perm_b32 v179, v254, v250, s46
    v_perm_b32 v183, v254, v250, s47
    v_perm_b32 v187, v255, v251, s46
    v_perm_b32 v191, v255, v251, s47
    ds_write_b128 v30, v[160:163] offset:0
    ds_write_b128 v30, v[164:167] offset:144
    ds_write_b128 v30, v[168:171] offset:288
    ds_write_b128 v30, v[172:175] offset:432
    ds_write_b128 v30, v[176:179] offset:576
    ds_write_b128 v30, v[180:183] offset:720
    ds_write_b128 v30, v[184:187] offset:864
    ds_write_b128 v30, v[188:191] offset:1008
    v_and_b32 v28, 15, v0
    v_lshrrev_b32 v29, 4, v0

    s_mul_i32 s55, s59, 9216
    s_add_u32 s55, s55, s39
    v_mul_u32_u24 v31, 576, v28
    v_add_u32 v31, s55, v31
    v_lshrrev_b32 v30, 1, v28
    v_xor_b32 v30, s59, v30
    v_xor_b32 v30, v30, v29
    v_lshl_add_u32 v32, v30, 4, v31
    v_xor_b32 v30, 4, v30
    v_lshl_add_u32 v33, v30, 4, v31

    s_waitcnt lgkmcnt(0)
    s_barrier
    ds_read_b128 v[64:67], v32 offset:0
    ds_read_b128 v[68:71], v33 offset:0
    ds_read_b128 v[72:75], v32 offset:144
    ds_read_b128 v[76:79], v33 offset:144
    ds_read_b128 v[80:83], v32 offset:288
    ds_read_b128 v[84:87], v33 offset:288
    ds_read_b128 v[88:91], v32 offset:432
    ds_read_b128 v[92:95], v33 offset:432
    s_waitcnt lgkmcnt(0)
    s_mov_b32 exec_lo, 0x11111111
    s_mov_b32 exec_hi, 0x11111111
    ds_read_b128 v[192:195], v1
    ds_read_b128 v[196:199], v1 offset:64
    s_mov_b64 exec, -1
    s_waitcnt lgkmcnt(1)
    v_mfma_f32_16x16x32_bf16 v[224:227], v[192:195], v[64:67], 0
    v_mfma_f32_16x16x32_bf16 v[228:231], v[192:195], v[72:75], 0
    v_mfma_f32_16x16x32_bf16 v[232:235], v[192:195], v[80:83], 0
    v_mfma_f32_16x16x32_bf16 v[236:239], v[192:195], v[88:91], 0
    s_waitcnt lgkmcnt(0)
    v_mfma_f32_16x16x32_bf16 v[224:227], v[196:199], v[68:71], v[224:227]
    v_mfma_f32_16x16x32_bf16 v[228:231], v[196:199], v[76:79], v[228:231]
    v_mfma_f32_16x16x32_bf16 v[232:235], v[196:199], v[84:87], v[232:235]
    v_mfma_f32_16x16x32_bf16 v[236:239], v[196:199], v[92:95], v[236:239]
    s_add_u32 s55, s54, 1
    s_and_b32 s55, s55, 0xbfffbfff
    v_mov_b32 v201, s55
    v_mov_b32 v203, s55
    s_nop 1
    v_cvt_pk_bf16_f32 v200, v224, v228
    s_nop 0
    v_cvt_pk_bf16_f32 v202, v232, v236
    v_lshlrev_b32 v9, 1, v2
    s_add_u32 s52, s48, 0x50000
    buffer_store_dwordx4 v[200:203], v9, s[12:15], s52 offen
    s_barrier
L_OJ:

    s_bfe_u32 s9, s5, 0x10001
    s_lshr_b32 s6, s5, 2
    s_lshl_b32 s6, s6, 1
    s_lshr_b32 s55, s7, 2
    s_add_u32 s6, s6, s55
    s_mul_i32 s39, s55, 36864

    s_lshl_b32 s3, s4, 19
    s_lshl_b32 s55, s9, 18
    s_add_u32 s3, s3, s55
    s_lshl_b32 s55, s59, 16
    s_add_u32 s3, s3, s55
    s_lshl_b32 s55, s6, 7
    s_add_u32 s3, s3, s55
    v_lshrrev_b32 v4, 3, v0
    v_lshlrev_b32 v4, 10, v4
    v_and_b32 v30, 7, v0
    v_lshl_add_u32 v4, v30, 4, v4
    v_add_u32 v4, s3, v4

    s_mov_b32 s52, 0
    buffer_load_dwordx4 v[224:227], v4, s[20:23], s52 offen nt
    s_mov_b32 s52, 8192
    buffer_load_dwordx4 v[228:231], v4, s[20:23], s52 offen nt
    s_mov_b32 s52, 16384
    buffer_load_dwordx4 v[232:235], v4, s[20:23], s52 offen nt
    s_mov_b32 s52, 24576
    buffer_load_dwordx4 v[236:239], v4, s[20:23], s52 offen nt
    s_barrier
    s_mov_b32 s52, 32768
    buffer_load_dwordx4 v[240:243], v4, s[20:23], s52 offen nt
    s_mov_b32 s52, 40960
    buffer_load_dwordx4 v[244:247], v4, s[20:23], s52 offen nt
    s_mov_b32 s52, 49152
    buffer_load_dwordx4 v[248:251], v4, s[20:23], s52 offen nt
    s_mov_b32 s52, 57344
    buffer_load_dwordx4 v[252:255], v4, s[20:23], s52 offen nt
    s_branch L_pg4
.p2align 12
L_pg4:
    v_and_b32 v28, 15, v0
    v_lshrrev_b32 v29, 4, v0

    v_lshrrev_b32 v217, 2, v28
    v_lshlrev_b32 v219, 4, v0
    s_lshl_b32 s3, s59, 2
    s_lshl_b32 s55, s9, 1
    s_add_u32 s3, s3, s55
    s_lshr_b32 s56, s7, 2
    s_add_u32 s3, s3, s56
    s_lshl_b32 s55, s3, 10
    v_add_u32 v1, s55, v219
    s_lshl_b32 s55, s3, 7
    v_add_u32 v2, v0, v29
    v_and_b32 v2, 3, v2
    v_lshlrev_b32 v2, 3, v2
    v_add_u32 v2, s55, v2
    s_mul_i32 s55, s59, 576
    s_mul_i32 s3, s56, 288
    s_add_u32 s55, s55, s3
    s_add_u32 s55, s55, 133120
    v_lshlrev_b32 v3, 4, v28
    v_lshl_add_u32 v3, v29, 3, v3
    v_lshrrev_b32 v216, 3, v28
    v_mul_u32_u24 v216, 16, v216
    v_add_u32 v3, v3, v216
    v_add_u32 v3, s55, v3
    v_lshlrev_b32 v216, 3, v0
    v_add_u32 v216, 136320, v216
    v_cndmask_b32 v3, v3, v216, s[50:51]
    v_and_b32 v216, 3, v0

    v_mul_u32_u24 v5, 576, v217
    v_mul_u32_u24 v219, 144, v216
    v_add_u32 v5, v5, v219

    v_lshl_add_u32 v5, v29, 4, v5
    v_add_u32 v5, 133120, v5
    s_lshl_b32 s55, s6, 14
    s_lshl_b32 s56, s59, 11
    s_add_u32 s55, s55, s56
    s_lshl_b32 s56, s4, 8
    s_add_u32 s55, s55, s56
    s_lshl_b32 s56, s9, 7
    s_add_u32 s55, s55, s56
    v_lshlrev_b32 v6, 5, v29
    v_lshl_add_u32 v6, v216, 3, v6
    v_and_b32 v219, 1, v217
    v_lshl_add_u32 v6, v219, 13, v6
    v_add_u32 v6, s55, v6

    v_and_b32 v219, 1, v28
    v_lshlrev_b32 v219, 4, v219
    v_mov_b32 v216, 0xffff
    v_lshlrev_b32 v216, v219, v216
    v_lshrrev_b32 v219, 1, v28

    v_cmp_eq_u32 vcc, 0, v219
    s_nop 1
    v_cndmask_b32 v24, 0, v216, vcc
    v_cmp_eq_u32 vcc, 1, v219
    s_nop 1
    v_cndmask_b32 v25, 0, v216, vcc
    v_cmp_eq_u32 vcc, 2, v219
    s_nop 1
    v_cndmask_b32 v26, 0, v216, vcc
    v_cmp_eq_u32 vcc, 3, v219
    s_nop 1
    v_cndmask_b32 v27, 0, v216, vcc
    s_add_u32 s52, s48, 0xc000
    s_add_u32 s57, s48, 0xf000
    s_add_u32 s57, s48, 0x17000
    buffer_load_dwordx4 v[12:15], v1, s[12:15], s57 offen offset:0 nt
    s_barrier

    s_lshl_b32 s55, s4, 8
    s_add_u32 s55, s55, 0x1b0000
    v_and_b32 v204, 31, v0
    v_lshlrev_b32 v204, 3, v204
    v_add_u32 v204, s55, v204

    buffer_load_dwordx2 v[206:207], v204, s[12:15], 0 offen sc1
    s_mov_b32 s52, 0
    buffer_load_dwordx4 v[128:131], v4, s[28:31], s52 offen nt
    s_mov_b32 s52, 8192
    buffer_load_dwordx4 v[132:135], v4, s[28:31], s52 offen nt

    v_and_b32 v30, 7, v0
    v_lshrrev_b32 v31, 3, v0
    v_xor_b32 v31, v31, v30
    v_mul_u32_u24 v30, 4224, v30
    v_lshl_add_u32 v30, v31, 4, v30
    s_lshl_b32 s55, s59, 7
    s_add_u32 s55, s55, s39
    v_add_u32 v30, s55, v30

    s_waitcnt vmcnt(10)
    v_perm_b32 v32, v228, v224, s46
    v_perm_b32 v36, v228, v224, s47
    v_perm_b32 v40, v229, v225, s46
    v_perm_b32 v44, v229, v225, s47
    v_perm_b32 v48, v230, v226, s46
    v_perm_b32 v52, v230, v226, s47
    v_perm_b32 v56, v231, v227, s46
    v_perm_b32 v60, v231, v227, s47
    s_waitcnt vmcnt(8)
    v_perm_b32 v33, v236, v232, s46
    v_perm_b32 v37, v236, v232, s47
    v_perm_b32 v41, v237, v233, s46
    v_perm_b32 v45, v237, v233, s47
    v_perm_b32 v49, v238, v234, s46
    v_perm_b32 v53, v238, v234, s47
    v_perm_b32 v57, v239, v235, s46
    v_perm_b32 v61, v239, v235, s47
    s_waitcnt vmcnt(6)
    v_perm_b32 v34, v244, v240, s46
    v_perm_b32 v38, v244, v240, s47
    v_perm_b32 v42, v245, v241, s46
    v_perm_b32 v46, v245, v241, s47
    v_perm_b32 v50, v246, v242, s46
    v_perm_b32 v54, v246, v242, s47
    v_perm_b32 v58, v247, v243, s46
    v_perm_b32 v62, v247, v243, s47
    s_waitcnt vmcnt(4)
    v_perm_b32 v35, v252, v248, s46
    v_perm_b32 v39, v252, v248, s47
    v_perm_b32 v43, v253, v249, s46
    v_perm_b32 v47, v253, v249, s47
    v_perm_b32 v51, v254, v250, s46
    v_perm_b32 v55, v254, v250, s47
    v_perm_b32 v59, v255, v251, s46
    v_perm_b32 v63, v255, v251, s47
    ds_write_b128 v30, v[32:35] offset:0
    ds_write_b128 v30, v[36:39] offset:528
    ds_write_b128 v30, v[40:43] offset:1056
    ds_write_b128 v30, v[44:47] offset:1584
    ds_write_b128 v30, v[48:51] offset:2112
    ds_write_b128 v30, v[52:55] offset:2640
    ds_write_b128 v30, v[56:59] offset:3168
    ds_write_b128 v30, v[60:63] offset:3696

    s_cmp_lg_u32 s7, 0
    s_cbranch_scc1 Low_57
    s_waitcnt vmcnt(2)
    s_add_u32 s55, s54, 1
    v_cmp_ne_u32 vcc, s55, v206
    v_cmp_ne_u32 s[98:99], s62, v207
    s_nop 0
    s_or_b64 vcc, vcc, s[98:99]
    s_mov_b32 s10, 1
    s_cbranch_vccz Lhw_58
    s_add_u32 s56, s54, 1
    s_mov_b32 s53, 0
Lp_62:
    buffer_load_dwordx2 v[206:207], v204, s[12:15], 0 offen sc1
    s_waitcnt vmcnt(0)
    v_cmp_ne_u32 vcc, s56, v206
    s_cbranch_vccz Lpd_63
    s_add_u32 s53, s53, 1
    s_cmp_lt_u32 s53, 64
    s_cbranch_scc1 Lp_62
Lpd_63:
    s_cbranch_vccnz Lhs_60
    v_cmp_ne_u32 vcc, s62, v207
    s_mov_b32 s10, 1
    s_cbranch_vccz Lhs_59
    s_branch Lhs_61
Lhs_60:

    s_lshl_b32 s55, s4, 12
    s_add_u32 s55, s55, 0x1a0000
    v_and_b32 v212, 31, v0
    v_lshlrev_b32 v212, 7, v212
    v_add_u32 v212, s55, v212

    s_mov_b32 s53, 0
Lp_64:
    buffer_load_dwordx2 v[206:207], v212, s[12:15], 0 offen sc1
    s_waitcnt vmcnt(0)
    v_cmp_ne_u32 vcc, s56, v206
    s_cbranch_vccz Lpd_65
    s_add_u32 s53, s53, 1
    s_cmp_lt_u32 s53, s11
    s_cbranch_scc1 Lp_64
    s_mov_b32 s11, 0
Lpd_65:
    v_cmp_ne_u32 vcc, s62, v207
    s_mov_b32 s10, 1
    s_cbranch_vccz Lhs_59
Lhs_61:
    s_mov_b32 s10, 0
    s_add_u32 s48, s48, 0x800000

    v_mov_b32 v212, -1
    v_mov_b32 v213, -1
    v_mov_b32 v214, -1
    v_mov_b32 v215, -1
    s_mul_i32 s55, s5, 5888
    s_add_u32 s55, s55, s48
    v_lshlrev_b32 v216, 4, v0

    buffer_store_dwordx4 v[212:215], v216, s[12:15], s55 offen sc1
    s_add_u32 s55, s55, 1024
    buffer_store_dwordx4 v[212:215], v216, s[12:15], s55 offen sc1
    s_add_u32 s55, s55, 1024
    buffer_store_dwordx4 v[212:215], v216, s[12:15], s55 offen sc1
    s_add_u32 s55, s55, 1024
    buffer_store_dwordx4 v[212:215], v216, s[12:15], s55 offen sc1
    s_add_u32 s55, s55, 1024
    buffer_store_dwordx4 v[212:215], v216, s[12:15], s55 offen sc1
    s_add_u32 s55, s55, 1024
    buffer_store_dwordx4 v[212:215], v216, s[12:15], s55 offen sc1
    s_add_u32 s55, s55, 1024
    buffer_store_dwordx4 v[212:215], v216, s[12:15], s55 offen sc1
    s_add_u32 s55, s55, 1024
    buffer_store_dwordx4 v[212:215], v216, s[12:15], s55 offen sc1
    s_add_u32 s55, s55, 1024
    buffer_store_dwordx4 v[212:215], v216, s[12:15], s55 offen sc1
    s_add_u32 s55, s55, 1024
    buffer_store_dwordx4 v[212:215], v216, s[12:15], s55 offen sc1
    s_add_u32 s55, s55, 1024
    buffer_store_dwordx4 v[212:215], v216, s[12:15], s55 offen sc1
    s_add_u32 s55, s55, 512
    buffer_store_dwordx4 v[212:215], v216, s[12:15], s55 offen sc1
    s_add_u32 s55, s55, 512
    s_waitcnt vmcnt(0)
    s_add_u32 s56, s54, 1
    v_mov_b32 v212, s56
    v_mov_b32 v213, s62
    v_mov_b32 v214, s56
    v_mov_b32 v215, s62

    s_lshl_b32 s55, s4, 12
    s_and_b32 s56, s2, 0xf8
    s_lshl_b32 s56, s56, 4
    s_add_u32 s55, s55, s56
    s_add_u32 s55, s55, 0x1a8000
    v_lshlrev_b32 v216, 4, v0
    s_mov_b64 exec, 0xff
    buffer_store_dwordx4 v[212:215], v216, s[12:15], s55 offen sc1
    s_mov_b64 exec, -1

    s_lshl_b32 s55, s4, 12
    s_add_u32 s55, s55, 0x1a8080
    v_and_b32 v218, 7, v0
    v_lshlrev_b32 v218, 9, v218
    v_add_u32 v218, s55, v218

    s_add_u32 s56, s54, 1
    s_mov_b32 s53, 0
Lp_66:
    buffer_load_dwordx2 v[206:207], v218, s[12:15], 0 offen sc1
    s_waitcnt vmcnt(0)
    v_cmp_ne_u32 vcc, s56, v206
    s_cbranch_vccz Lpd_67
    s_add_u32 s53, s53, 1
    s_cmp_lt_u32 s53, s11
    s_cbranch_scc1 Lp_66
    s_mov_b32 s11, 0
Lpd_67:
Lhs_59:
Lhw_58:
    v_mov_b32 v30, s10
    v_mov_b32 v31, 136260
    ds_write_b32 v31, v30
    s_lshl_b32 s48, s4, 19
    s_add_u32 s48, s48, 0x200000
    s_waitcnt lgkmcnt(0)
Low_57:
    s_waitcnt lgkmcnt(0)
    s_barrier
    v_mov_b32 v30, 136260
    ds_read_b32 v30, v30
    s_waitcnt lgkmcnt(0)
    v_readfirstlane_b32 s10, v30
    s_nop 0
    s_cmp_eq_u32 s10, 0
    s_cselect_b32 s55, 0x800000, 0
    s_add_u32 s48, s48, s55
    s_cmp_lt_u32 s7, 4
    s_cbranch_scc1 Lq3_68
    s_cmp_lg_u32 s10, 0
    s_cbranch_scc1 Lq2_69
    s_add_u32 s52, s48, 0x50000
    buffer_store_dwordx4 v[200:203], v9, s[12:15], s52 offen sc1
    s_nop 1
Lq2_69:
Lq3_68:
    v_and_b32 v28, 15, v0
    v_lshrrev_b32 v29, 4, v0

    s_mul_i32 s55, s59, 8448
    s_add_u32 s55, s55, s39
    v_and_b32 v31, 3, v28
    v_mul_u32_u24 v30, 2112, v31
    v_add_u32 v30, s55, v30
    v_lshrrev_b32 v28, 2, v28
    v_lshl_add_u32 v30, v28, 7, v30
    v_lshrrev_b32 v31, 1, v31
    s_lshl_b32 s55, s59, 1
    v_add_u32 v31, s55, v31
    v_xor_b32 v31, v31, v29
    v_xor_b32 v29, 4, v31
    v_lshl_add_u32 v29, v29, 4, v30
    v_lshl_add_u32 v30, v31, 4, v30

    ds_read_b128 v[64:67], v30 offset:0
    ds_read_b128 v[68:71], v29 offset:0
    ds_read_b128 v[72:75], v30 offset:528
    ds_read_b128 v[76:79], v29 offset:528
    ds_read_b128 v[80:83], v30 offset:1056
    ds_read_b128 v[84:87], v29 offset:1056
    ds_read_b128 v[88:91], v30 offset:1584
    ds_read_b128 v[92:95], v29 offset:1584

    v_mov_b32 v16, -1
    v_mov_b32 v17, -1
    v_mov_b32 v18, -1
    v_mov_b32 v19, -1
    v_bfe_u32 v20, v0, 3, 1
    v_lshlrev_b32 v20, 13, v20
    v_and_b32 v30, 7, v0
    v_lshl_add_u32 v20, v30, 4, v20
    v_readfirstlane_b32 s55, v6
    s_nop 0
    s_add_u32 s55, s55, 131072
    v_add_u32 v20, s55, v20
    v_add_u32 v21, 16384, v1

    s_add_u32 s52, s48, 0xc000
    s_add_u32 s57, s48, 0xf000
    s_mov_b32 s32, 0
    s_lshl_b32 s55, s5, 6
    s_add_u32 s55, s55, 64
    v_mov_b32 v8, s55
    s_mov_b32 s33, 0x100000

L_oloop:
    s_mov_b32 s53, 0
Lp_70:
    buffer_load_dwordx2 v[232:233], v2, s[12:15], s52 offen sc1
    buffer_load_dwordx4 v[224:227], v1, s[12:15], s57 offen offset:0 sc1
    s_waitcnt vmcnt(1)
    v_cmp_eq_u32 vcc, -1, v232
    s_cbranch_vccz Lpd_71
    s_add_u32 s53, s53, 1
    s_cmp_lt_u32 s53, s11
    s_cbranch_scc1 Lp_70
    s_mov_b32 s11, 0
Lpd_71:
    buffer_load_dword v238, v2, s[12:15], s52 offen offset:4 sc1
    buffer_load_dwordx4 v[228:231], v1, s[12:15], s57 offen offset:0 sc1
    v_max_f32_dpp v234, v232, v232 quad_perm:[1,0,3,2] row_mask:0xf bank_mask:0xf
    s_nop 1
    v_max_f32_dpp v234, v234, v234 quad_perm:[2,3,0,1] row_mask:0xf bank_mask:0xf
    v_sub_f32 v235, v232, v234
    v_exp_f32 v235, v235
    s_nop 0
    v_cvt_pk_bf16_f32 v235, v235, v235
    v_and_b32 v234, 0xffff0000, v235
    s_nop 0
    v_and_b32_dpp v240, v235, v24 row_newbcast:0 row_mask:0xf bank_mask:0xf
    v_and_b32_dpp v241, v235, v25 row_newbcast:0 row_mask:0xf bank_mask:0xf
    v_and_b32_dpp v242, v235, v26 row_newbcast:0 row_mask:0xf bank_mask:0xf
    v_and_b32_dpp v243, v235, v27 row_newbcast:0 row_mask:0xf bank_mask:0xf
    s_mov_b32 s53, 0
Lo_72:
    s_waitcnt vmcnt(3)
    v_mul_f32 v236, v234, v233
    s_waitcnt vmcnt(2)
    v_mfma_f32_16x16x32_bf16 v[248:251], v[240:243], v[224:227], 0
    v_add_f32_dpp v236, v236, v236 quad_perm:[1,0,3,2] row_mask:0xf bank_mask:0xf
    v_max3_u32 v28, v233, v224, v225
    v_max3_u32 v28, v28, v226, v227
    v_add_f32_dpp v236, v236, v236 quad_perm:[2,3,0,1] row_mask:0xf bank_mask:0xf
    v_cmp_eq_u32 vcc, -1, v28
    v_rcp_f32 v236, v236
    s_cbranch_vccz Lod_74
    buffer_load_dword v233, v2, s[12:15], s52 offen offset:4 sc1
    buffer_load_dwordx4 v[224:227], v1, s[12:15], s57 offen offset:0 sc1
    s_waitcnt vmcnt(3)
    v_mul_f32 v236, v234, v238
    s_waitcnt vmcnt(2)
    v_mfma_f32_16x16x32_bf16 v[248:251], v[240:243], v[228:231], 0
    v_add_f32_dpp v236, v236, v236 quad_perm:[1,0,3,2] row_mask:0xf bank_mask:0xf
    v_max3_u32 v28, v238, v228, v229
    v_max3_u32 v28, v28, v230, v231
    v_add_f32_dpp v236, v236, v236 quad_perm:[2,3,0,1] row_mask:0xf bank_mask:0xf
    v_cmp_eq_u32 vcc, -1, v28
    v_rcp_f32 v236, v236
    s_cbranch_vccz Lod_74
    buffer_load_dword v238, v2, s[12:15], s52 offen offset:4 sc1
    buffer_load_dwordx4 v[228:231], v1, s[12:15], s57 offen offset:0 sc1
    s_add_u32 s53, s53, 1
    s_cmp_lt_u32 s53, s11
    s_cbranch_scc1 Lo_72
    s_mov_b32 s11, 0
Lod_74:
    s_nop 0
    v_pk_mul_f32 v[248:249], v[248:249], v[236:237] op_sel:[0,0] op_sel_hi:[1,0]
    v_pk_mul_f32 v[250:251], v[250:251], v[236:237] op_sel:[0,0] op_sel_hi:[1,0]
    v_cvt_pk_bf16_f32 v248, v248, v249
    v_cvt_pk_bf16_f32 v249, v250, v251
    ds_write_b64 v3, v[248:249]
    s_waitcnt lgkmcnt(0)
    s_barrier
    ds_read_b128 v[192:195], v5
    ds_read_b128 v[196:199], v5 offset:64
    s_waitcnt lgkmcnt(1)
    v_mfma_f32_16x16x32_bf16 v[32:35], v[192:195], v[64:67], 0
    v_mfma_f32_16x16x32_bf16 v[36:39], v[192:195], v[72:75], 0
    v_mfma_f32_16x16x32_bf16 v[40:43], v[192:195], v[80:83], 0
    v_mfma_f32_16x16x32_bf16 v[44:47], v[192:195], v[88:91], 0
    s_waitcnt lgkmcnt(0)
    v_mfma_f32_16x16x32_bf16 v[32:35], v[196:199], v[68:71], v[32:35]
    v_mfma_f32_16x16x32_bf16 v[36:39], v[196:199], v[76:79], v[36:39]
    v_mfma_f32_16x16x32_bf16 v[40:43], v[196:199], v[84:87], v[40:43]
    v_mfma_f32_16x16x32_bf16 v[44:47], v[196:199], v[92:95], v[44:47]
    s_nop 4
    v_add_f32_dpp v32, v33, v32 row_shl:4 row_mask:0xf bank_mask:0xf
    v_add_f32_dpp v34, v35, v34 row_shl:4 row_mask:0xf bank_mask:0xf
    v_add_f32_dpp v36, v37, v36 row_shl:4 row_mask:0xf bank_mask:0xf
    v_add_f32_dpp v38, v39, v38 row_shl:4 row_mask:0xf bank_mask:0xf
    v_add_f32_dpp v40, v41, v40 row_shl:4 row_mask:0xf bank_mask:0xf
    v_add_f32_dpp v42, v43, v42 row_shl:4 row_mask:0xf bank_mask:0xf
    v_add_f32_dpp v44, v45, v44 row_shl:4 row_mask:0xf bank_mask:0xf
    v_add_f32_dpp v46, v47, v46 row_shl:4 row_mask:0xf bank_mask:0xf
    v_add_f32_dpp v32, v34, v32 row_shl:8 row_mask:0xf bank_mask:0xf
    v_add_f32_dpp v36, v38, v36 row_shl:8 row_mask:0xf bank_mask:0xf
    v_add_f32_dpp v40, v42, v40 row_shl:8 row_mask:0xf bank_mask:0xf
    v_add_f32_dpp v44, v46, v44 row_shl:8 row_mask:0xf bank_mask:0xf
    v_cvt_pk_bf16_f32 v200, v32, v36
    v_cvt_pk_bf16_f32 v201, v40, v44
    s_mov_b32 exec_lo, 0xff00ff
    s_mov_b32 exec_hi, 0xff00ff
    v_mov_b32_dpp v200, v200 row_shr:4 row_mask:0xf bank_mask:0x2
    v_mov_b32_dpp v201, v201 row_shr:4 row_mask:0xf bank_mask:0x2
    buffer_store_dwordx2 v[200:201], v6, s[12:15], s33 offen sc1
    s_mov_b64 exec, -1
    s_cmp_eq_u32 s32, 3
    s_cbranch_scc1 L_oend
    s_barrier

    s_add_u32 s33, s33, 131072
    s_add_u32 s57, s57, 16384
    s_add_u32 s34, s52, 2048
    s_add_u32 s32, s32, 1
    s_cmp_eq_u32 s32, 3
    s_cbranch_scc1 L_onc
    s_cmp_eq_u32 s10, 0
    s_cbranch_scc1 Lst_75
    buffer_store_dwordx4 v[16:19], v21, s[12:15], s57 offen
    s_branch Lst_76
Lst_75:
    buffer_store_dwordx4 v[16:19], v21, s[12:15], s57 offen sc1
Lst_76:
    s_mov_b64 exec, 0xffff
    buffer_store_dwordx4 v[16:19], v20, s[12:15], s33 offen sc1
    s_mov_b64 exec, -1
L_onc:
    buffer_load_dwordx2 v[12:13], v2, s[12:15], s34 offen sc1
    buffer_load_dwordx4 v[12:15], v1, s[12:15], s57 offen offset:0 sc1
    s_cmp_lg_u32 s32, 1
    s_cbranch_scc1 L_osw
    s_mov_b32 s52, 16384
    buffer_load_dwordx4 v[136:139], v4, s[28:31], s52 offen nt
    s_mov_b32 s52, 24576
    buffer_load_dwordx4 v[140:143], v4, s[28:31], s52 offen nt
    s_mov_b32 s52, 32768
    buffer_load_dwordx4 v[144:147], v4, s[28:31], s52 offen nt
    s_mov_b32 s52, 40960
    buffer_load_dwordx4 v[148:151], v4, s[28:31], s52 offen nt
    s_mov_b32 s52, 49152
    buffer_load_dwordx4 v[152:155], v4, s[28:31], s52 offen nt
    s_mov_b32 s52, 57344
    buffer_load_dwordx4 v[156:159], v4, s[28:31], s52 offen nt

    v_and_b32 v30, 7, v0
    v_lshrrev_b32 v31, 3, v0
    v_xor_b32 v31, v31, v30
    v_mul_u32_u24 v30, 4224, v30
    v_lshl_add_u32 v30, v31, 4, v30
    s_lshl_b32 s55, s59, 7
    s_add_u32 s55, s55, s39
    v_add_u32 v30, s55, v30

    v_perm_b32 v32, v132, v128, s46
    v_perm_b32 v36, v132, v128, s47
    v_perm_b32 v40, v133, v129, s46
    v_perm_b32 v44, v133, v129, s47
    v_perm_b32 v48, v134, v130, s46
    v_perm_b32 v52, v134, v130, s47
    v_perm_b32 v56, v135, v131, s46
    v_perm_b32 v60, v135, v131, s47
    s_waitcnt vmcnt(4)
    v_perm_b32 v33, v140, v136, s46
    v_perm_b32 v37, v140, v136, s47
    v_perm_b32 v41, v141, v137, s46
    v_perm_b32 v45, v141, v137, s47
    v_perm_b32 v49, v142, v138, s46
    v_perm_b32 v53, v142, v138, s47
    v_perm_b32 v57, v143, v139, s46
    v_perm_b32 v61, v143, v139, s47
    s_waitcnt vmcnt(2)
    v_perm_b32 v34, v148, v144, s46
    v_perm_b32 v38, v148, v144, s47
    v_perm_b32 v42, v149, v145, s46
    v_perm_b32 v46, v149, v145, s47
    v_perm_b32 v50, v150, v146, s46
    v_perm_b32 v54, v150, v146, s47
    v_perm_b32 v58, v151, v147, s46
    v_perm_b32 v62, v151, v147, s47
    s_waitcnt vmcnt(0)
    v_perm_b32 v35, v156, v152, s46
    v_perm_b32 v39, v156, v152, s47
    v_perm_b32 v43, v157, v153, s46
    v_perm_b32 v47, v157, v153, s47
    v_perm_b32 v51, v158, v154, s46
    v_perm_b32 v55, v158, v154, s47
    v_perm_b32 v59, v159, v155, s46
    v_perm_b32 v63, v159, v155, s47
    ds_write_b128 v30, v[32:35] offset:0
    ds_write_b128 v30, v[36:39] offset:528
    ds_write_b128 v30, v[40:43] offset:1056
    ds_write_b128 v30, v[44:47] offset:1584
    ds_write_b128 v30, v[48:51] offset:2112
    ds_write_b128 v30, v[52:55] offset:2640
    ds_write_b128 v30, v[56:59] offset:3168
    ds_write_b128 v30, v[60:63] offset:3696
    s_waitcnt lgkmcnt(0)
    s_barrier
    v_and_b32 v28, 15, v0
    v_lshrrev_b32 v29, 4, v0

    s_mul_i32 s55, s59, 8448
    s_add_u32 s55, s55, s39
    v_and_b32 v31, 3, v28
    v_mul_u32_u24 v30, 2112, v31
    v_add_u32 v30, s55, v30
    v_lshrrev_b32 v28, 2, v28
    v_lshl_add_u32 v30, v28, 7, v30
    v_lshrrev_b32 v31, 1, v31
    s_lshl_b32 s55, s59, 1
    v_add_u32 v31, s55, v31
    v_xor_b32 v31, v31, v29
    v_xor_b32 v29, 4, v31
    v_lshl_add_u32 v29, v29, 4, v30
    v_lshl_add_u32 v30, v31, 4, v30

    ds_read_b128 v[96:99], v30 offset:0
    ds_read_b128 v[100:103], v29 offset:0
    ds_read_b128 v[104:107], v30 offset:528
    ds_read_b128 v[108:111], v29 offset:528
    ds_read_b128 v[112:115], v30 offset:1056
    ds_read_b128 v[116:119], v29 offset:1056
    ds_read_b128 v[120:123], v30 offset:1584
    ds_read_b128 v[124:127], v29 offset:1584
    s_waitcnt lgkmcnt(0)
L_osw:
    s_mov_b32 s52, s34
    v_swap_b32 v64, v96
    v_swap_b32 v65, v97
    v_swap_b32 v66, v98
    v_swap_b32 v67, v99
    v_swap_b32 v68, v100
    v_swap_b32 v69, v101
    v_swap_b32 v70, v102
    v_swap_b32 v71, v103
    v_swap_b32 v72, v104
    v_swap_b32 v73, v105
    v_swap_b32 v74, v106
    v_swap_b32 v75, v107
    v_swap_b32 v76, v108
    v_swap_b32 v77, v109
    v_swap_b32 v78, v110
    v_swap_b32 v79, v111
    v_swap_b32 v80, v112
    v_swap_b32 v81, v113
    v_swap_b32 v82, v114
    v_swap_b32 v83, v115
    v_swap_b32 v84, v116
    v_swap_b32 v85, v117
    v_swap_b32 v86, v118
    v_swap_b32 v87, v119
    v_swap_b32 v88, v120
    v_swap_b32 v89, v121
    v_swap_b32 v90, v122
    v_swap_b32 v91, v123
    v_swap_b32 v92, v124
    v_swap_b32 v93, v125
    v_swap_b32 v94, v126
    v_swap_b32 v95, v127
    s_branch L_oloop
L_oend:
    s_endpgm
.p2align 12
L_pg5:
L_Q:
    s_lshr_b32 s9, s7, 2

    s_lshl_b32 s3, s6, 19
    s_lshl_b32 s55, s59, 17
    s_add_u32 s3, s3, s55
    s_lshl_b32 s55, s4, 10
    s_add_u32 s3, s3, s55
    s_lshl_b32 s55, s9, 9
    s_add_u32 s3, s3, s55
    v_lshrrev_b32 v4, 5, v0
    v_lshlrev_b32 v4, 16, v4
    v_and_b32 v30, 31, v0
    v_lshl_add_u32 v4, v30, 4, v4
    v_add_u32 v4, s3, v4

    s_mul_i32 s39, s9, 36864
    v_and_b32 v28, 15, v0
    v_lshrrev_b32 v29, 4, v0

    v_lshrrev_b32 v217, 2, v28
    v_and_b32 v218, 7, v0
    v_lshlrev_b32 v219, 4, v0
    v_mul_u32_u24 v1, 192, v217
    v_lshl_add_u32 v1, v29, 4, v1
    v_add_u32 v1, 135424, v1
    s_lshl_b32 s55, s9, 12
    s_lshr_b32 s56, s59, 1
    s_lshl_b32 s56, s56, 11
    s_add_u32 s55, s55, s56
    s_and_b32 s56, s59, 1
    s_lshl_b32 s56, s56, 7
    s_add_u32 s55, s55, s56
    s_lshl_b32 s56, s6, 8
    s_add_u32 s55, s55, s56
    v_lshlrev_b32 v2, 13, v29
    v_lshl_add_u32 v2, v28, 3, v2
    v_add_u32 v2, s55, v2

    v_mov_b32 v30, 0
    v_mov_b32 v31, 136192
    ds_write_b32 v31, v30
    s_waitcnt lgkmcnt(0)

    s_cmp_lg_u32 s7, 0
    s_cbranch_scc1 Low_77
    s_add_u32 s56, s54, 1
    v_mov_b32 v196, s56
    v_mov_b32 v197, s62

    s_lshl_b32 s55, s4, 8
    s_and_b32 s56, s2, 0xf8
    s_add_u32 s55, s55, s56
    s_add_u32 s55, s55, 0x1b0000
    v_mov_b32 v198, 0
    s_mov_b64 exec, 1
    buffer_store_dwordx2 v[196:197], v198, s[12:15], s55 offen
    s_mov_b64 exec, -1

    s_add_u32 s56, s54, 1
    v_mov_b32 v216, s56
    v_mov_b32 v217, s62
    v_mov_b32 v218, s56
    v_mov_b32 v219, s62

    s_lshl_b32 s55, s4, 12
    s_and_b32 s56, s2, 0xf8
    s_lshl_b32 s56, s56, 4
    s_add_u32 s55, s55, s56
    s_add_u32 s55, s55, 0x1a0000
    v_lshlrev_b32 v220, 4, v0
    s_mov_b64 exec, 0xff
    buffer_store_dwordx4 v[216:219], v220, s[12:15], s55 offen sc1
    s_mov_b64 exec, -1

Low_77:

    v_bfe_u32 v30, v0, 2, 1
    v_lshlrev_b32 v30, 12, v30
    v_and_b32 v31, 3, v0
    v_lshl_add_u32 v30, v31, 7, v30
    s_lshr_b32 s55, s5, 1
    s_lshl_b32 s55, s55, 9
    s_lshl_b32 s56, s59, 14
    s_add_u32 s55, s55, s56
    s_add_u32 s55, s55, s48
    s_add_u32 s55, s55, 0x52000
    s_mov_b64 exec, 0xff
    buffer_load_dword v13, v30, s[12:15], s55 offen nt
    s_mov_b64 exec, -1

    s_barrier
    s_mov_b32 s52, 0
    buffer_load_dwordx4 v[128:131], v4, s[16:19], s52 offen
    s_mov_b32 s52, 8192
    buffer_load_dwordx4 v[132:135], v4, s[16:19], s52 offen
    s_mov_b32 s52, 16384
    buffer_load_dwordx4 v[136:139], v4, s[16:19], s52 offen
    s_mov_b32 s52, 24576
    buffer_load_dwordx4 v[140:143], v4, s[16:19], s52 offen
    s_mov_b32 s52, 32768
    buffer_load_dwordx4 v[144:147], v4, s[16:19], s52 offen
    s_mov_b32 s52, 40960
    buffer_load_dwordx4 v[148:151], v4, s[16:19], s52 offen
    s_mov_b32 s52, 49152
    buffer_load_dwordx4 v[152:155], v4, s[16:19], s52 offen
    s_mov_b32 s52, 57344
    buffer_load_dwordx4 v[156:159], v4, s[16:19], s52 offen

    s_waitcnt vmcnt(9)
    s_waitcnt lgkmcnt(0)
    v_lshlrev_b32 v32, 16, v204
    v_and_b32 v33, 0xffff0000, v204
    v_lshlrev_b32 v34, 16, v205
    v_and_b32 v35, 0xffff0000, v205
    v_lshlrev_b32 v36, 16, v206
    v_and_b32 v37, 0xffff0000, v206
    v_lshlrev_b32 v38, 16, v207
    v_and_b32 v39, 0xffff0000, v207
    v_add_f32 v212, v32, v33
    v_add_f32 v212, v212, v34
    v_add_f32 v212, v212, v35
    v_add_f32 v212, v212, v36
    v_add_f32 v212, v212, v37
    v_add_f32 v212, v212, v38
    v_add_f32 v212, v212, v39
    s_nop 1
    v_add_f32_dpp v212, v212, v212 quad_perm:[1,0,3,2] row_mask:0xf bank_mask:0xf
    s_nop 1
    v_add_f32_dpp v212, v212, v212 quad_perm:[2,3,0,1] row_mask:0xf bank_mask:0xf
    s_nop 1
    v_add_f32_dpp v212, v212, v212 row_half_mirror row_mask:0xf bank_mask:0xf
    s_nop 1
    v_add_f32_dpp v212, v212, v212 row_mirror row_mask:0xf bank_mask:0xf
    v_mov_b32 v214, v212
    s_nop 1
    v_permlane16_swap_b32 v212, v214
    v_add_f32 v212, v212, v214
    v_mov_b32 v214, v212
    s_nop 1
    v_permlane32_swap_b32 v212, v214
    v_add_f32 v212, v212, v214
    v_mul_f32 v212, 0x3b000000, v212
    v_sub_f32 v32, v32, v212
    v_sub_f32 v33, v33, v212
    v_sub_f32 v34, v34, v212
    v_sub_f32 v35, v35, v212
    v_sub_f32 v36, v36, v212
    v_sub_f32 v37, v37, v212
    v_sub_f32 v38, v38, v212
    v_sub_f32 v39, v39, v212
    v_mul_f32 v213, v32, v32
    v_fmac_f32 v213, v33, v33
    v_fmac_f32 v213, v34, v34
    v_fmac_f32 v213, v35, v35
    v_fmac_f32 v213, v36, v36
    v_fmac_f32 v213, v37, v37
    v_fmac_f32 v213, v38, v38
    v_fmac_f32 v213, v39, v39
    s_nop 1
    v_add_f32_dpp v213, v213, v213 quad_perm:[1,0,3,2] row_mask:0xf bank_mask:0xf
    s_nop 1
    v_add_f32_dpp v213, v213, v213 quad_perm:[2,3,0,1] row_mask:0xf bank_mask:0xf
    s_nop 1
    v_add_f32_dpp v213, v213, v213 row_half_mirror row_mask:0xf bank_mask:0xf
    s_nop 1
    v_add_f32_dpp v213, v213, v213 row_mirror row_mask:0xf bank_mask:0xf
    v_mov_b32 v214, v213
    s_nop 1
    v_permlane16_swap_b32 v213, v214
    v_add_f32 v213, v213, v214
    v_mov_b32 v214, v213
    s_nop 1
    v_permlane32_swap_b32 v213, v214
    v_add_f32 v213, v213, v214
    v_mul_f32 v213, 0x3b000000, v213
    v_cvt_pk_bf16_f32 v214, v212, v212
    v_lshlrev_b32 v212, 16, v214
    v_cvt_pk_bf16_f32 v214, v213, v213
    v_lshlrev_b32 v213, 16, v214
    v_add_f32 v213, 0x3727c5ac, v213
    v_cvt_pk_bf16_f32 v214, v213, v213
    v_lshlrev_b32 v213, 16, v214
    v_sqrt_f32 v213, v213
    s_nop 0
    v_cvt_pk_bf16_f32 v214, v213, v213
    v_lshlrev_b32 v213, 16, v214
    v_rcp_f32 v213, v213
    s_mul_i32 s55, s59, 192
    s_add_u32 s55, s55, 135424
    v_lshlrev_b32 v210, 1, v0
    v_add_u32 v210, s55, v210
    v_lshlrev_b32 v209, 16, v208
    v_sub_f32 v209, v209, v212
    v_cvt_pk_bf16_f32 v214, v209, v209
    v_lshlrev_b32 v209, 16, v214
    v_mul_f32 v209, v209, v213
    v_cvt_pk_bf16_f32 v209, v209, v209
    ds_write_b16 v210, v209
    s_waitcnt lgkmcnt(0)
    s_barrier

    s_lshl_b32 s3, s4, 19
    s_and_b32 s55, s6, 1
    s_lshl_b32 s55, s55, 18
    s_add_u32 s3, s3, s55
    s_lshl_b32 s55, s59, 16
    s_add_u32 s3, s3, s55
    s_and_b32 s55, s6, 6
    s_add_u32 s55, s55, s9
    s_lshl_b32 s55, s55, 7
    s_add_u32 s3, s3, s55
    v_lshrrev_b32 v16, 3, v0
    v_lshlrev_b32 v16, 10, v16
    v_and_b32 v30, 7, v0
    v_lshl_add_u32 v16, v30, 4, v16
    v_add_u32 v16, s3, v16

    s_barrier
    s_mov_b32 s52, 32768
    buffer_load_dwordx4 v[12:15], v16, s[20:23], s52 offen
    s_mov_b32 s52, 40960
    buffer_load_dwordx4 v[12:15], v16, s[20:23], s52 offen
    s_mov_b32 s52, 49152
    buffer_load_dwordx4 v[12:15], v16, s[20:23], s52 offen
    s_mov_b32 s52, 57344
    buffer_load_dwordx4 v[12:15], v16, s[20:23], s52 offen
    s_barrier
    s_mov_b32 s52, 0
    buffer_load_dwordx4 v[224:227], v4, s[24:27], s52 offen nt
    s_mov_b32 s52, 8192
    buffer_load_dwordx4 v[228:231], v4, s[24:27], s52 offen nt
    s_mov_b32 s52, 16384
    buffer_load_dwordx4 v[232:235], v4, s[24:27], s52 offen nt
    s_mov_b32 s52, 24576
    buffer_load_dwordx4 v[236:239], v4, s[24:27], s52 offen nt
    s_mov_b32 s52, 32768
    buffer_load_dwordx4 v[240:243], v4, s[24:27], s52 offen nt
    s_mov_b32 s52, 40960
    buffer_load_dwordx4 v[244:247], v4, s[24:27], s52 offen nt
    s_mov_b32 s52, 49152
    buffer_load_dwordx4 v[248:251], v4, s[24:27], s52 offen nt
    s_mov_b32 s52, 57344
    buffer_load_dwordx4 v[252:255], v4, s[24:27], s52 offen nt

    s_add_u32 s57, s48, 0x1f000
    buffer_load_dwordx2 v[12:13], v2, s[12:15], s57 offen nt
    s_mov_b32 s39, 73728

    v_and_b32 v30, 31, v0
    v_lshrrev_b32 v31, 3, v30
    v_xor_b32 v31, v31, v30
    v_lshrrev_b32 v29, 5, v0
    v_xor_b32 v31, v31, v29
    s_lshl_b32 s55, s59, 1
    v_xor_b32 v31, s55, v31
    v_and_b32 v31, 7, v31
    v_mul_u32_u24 v30, 1152, v30
    v_lshl_add_u32 v30, v31, 4, v30
    v_add_u32 v30, s39, v30

    s_waitcnt vmcnt(19)
    v_perm_b32 v160, v132, v128, s46
    v_perm_b32 v164, v132, v128, s47
    v_perm_b32 v168, v133, v129, s46
    v_perm_b32 v172, v133, v129, s47
    v_perm_b32 v176, v134, v130, s46
    v_perm_b32 v180, v134, v130, s47
    v_perm_b32 v184, v135, v131, s46
    v_perm_b32 v188, v135, v131, s47
    s_waitcnt vmcnt(17)
    v_perm_b32 v161, v140, v136, s46
    v_perm_b32 v165, v140, v136, s47
    v_perm_b32 v169, v141, v137, s46
    v_perm_b32 v173, v141, v137, s47
    v_perm_b32 v177, v142, v138, s46
    v_perm_b32 v181, v142, v138, s47
    v_perm_b32 v185, v143, v139, s46
    v_perm_b32 v189, v143, v139, s47
    s_waitcnt vmcnt(15)
    v_perm_b32 v162, v148, v144, s46
    v_perm_b32 v166, v148, v144, s47
    v_perm_b32 v170, v149, v145, s46
    v_perm_b32 v174, v149, v145, s47
    v_perm_b32 v178, v150, v146, s46
    v_perm_b32 v182, v150, v146, s47
    v_perm_b32 v186, v151, v147, s46
    v_perm_b32 v190, v151, v147, s47
    s_waitcnt vmcnt(13)
    v_perm_b32 v163, v156, v152, s46
    v_perm_b32 v167, v156, v152, s47
    v_perm_b32 v171, v157, v153, s46
    v_perm_b32 v175, v157, v153, s47
    v_perm_b32 v179, v158, v154, s46
    v_perm_b32 v183, v158, v154, s47
    v_perm_b32 v187, v159, v155, s46
    v_perm_b32 v191, v159, v155, s47
    ds_write_b128 v30, v[160:163] offset:0
    ds_write_b128 v30, v[164:167] offset:144
    ds_write_b128 v30, v[168:171] offset:288
    ds_write_b128 v30, v[172:175] offset:432
    ds_write_b128 v30, v[176:179] offset:576
    ds_write_b128 v30, v[180:183] offset:720
    ds_write_b128 v30, v[184:187] offset:864
    ds_write_b128 v30, v[188:191] offset:1008
    s_mov_b32 s39, 0
    s_waitcnt lgkmcnt(0)

    s_lshl_b32 s60, s6, 14
    s_lshl_b32 s55, s4, 8
    s_add_u32 s60, s60, s55
    s_add_u32 s60, s60, 0x100000

    s_cmp_lg_u32 s7, 1
    s_cbranch_scc1 Low_78
    s_mov_b32 s24, -1
    s_mov_b32 s25, -1

    s_add_u32 s52, s60, 0
    s_memtime s[26:27]
    s_waitcnt lgkmcnt(0)
    s_load_dword s30, s[40:41], s52 glc
    s_waitcnt lgkmcnt(0)
    s_memtime s[28:29]
    s_waitcnt lgkmcnt(0)
    s_sub_u32 s28, s28, s26
    s_min_u32 s24, s24, s28

    s_add_u32 s52, s60, 8192
    s_memtime s[26:27]
    s_waitcnt lgkmcnt(0)
    s_load_dword s30, s[40:41], s52 glc
    s_waitcnt lgkmcnt(0)
    s_memtime s[28:29]
    s_waitcnt lgkmcnt(0)
    s_sub_u32 s28, s28, s26
    s_min_u32 s25, s25, s28

    s_add_u32 s52, s60, 2048
    s_memtime s[26:27]
    s_waitcnt lgkmcnt(0)
    s_load_dword s30, s[40:41], s52 glc
    s_waitcnt lgkmcnt(0)
    s_memtime s[28:29]
    s_waitcnt lgkmcnt(0)
    s_sub_u32 s28, s28, s26
    s_min_u32 s24, s24, s28

    s_add_u32 s52, s60, 10240
    s_memtime s[26:27]
    s_waitcnt lgkmcnt(0)
    s_load_dword s30, s[40:41], s52 glc
    s_waitcnt lgkmcnt(0)
    s_memtime s[28:29]
    s_waitcnt lgkmcnt(0)
    s_sub_u32 s28, s28, s26
    s_min_u32 s25, s25, s28

    s_add_u32 s52, s60, 4096
    s_memtime s[26:27]
    s_waitcnt lgkmcnt(0)
    s_load_dword s30, s[40:41], s52 glc
    s_waitcnt lgkmcnt(0)
    s_memtime s[28:29]
    s_waitcnt lgkmcnt(0)
    s_sub_u32 s28, s28, s26
    s_min_u32 s24, s24, s28

    s_add_u32 s52, s60, 12288
    s_memtime s[26:27]
    s_waitcnt lgkmcnt(0)
    s_load_dword s30, s[40:41], s52 glc
    s_waitcnt lgkmcnt(0)
    s_memtime s[28:29]
    s_waitcnt lgkmcnt(0)
    s_sub_u32 s28, s28, s26
    s_min_u32 s25, s25, s28

    s_cmp_lt_u32 s25, s24
    s_cselect_b32 s55, 0x2000, 0
    v_mov_b32 v30, s55
    v_mov_b32 v31, 136256
    ds_write_b32 v31, v30
    s_waitcnt lgkmcnt(0)
Low_78:

    v_and_b32 v30, 31, v0
    v_lshrrev_b32 v31, 3, v30
    v_xor_b32 v31, v31, v30
    v_lshrrev_b32 v29, 5, v0
    v_xor_b32 v31, v31, v29
    s_lshl_b32 s55, s59, 1
    v_xor_b32 v31, s55, v31
    v_and_b32 v31, 7, v31
    v_mul_u32_u24 v30, 1152, v30
    v_lshl_add_u32 v30, v31, 4, v30
    v_add_u32 v30, s39, v30

    s_waitcnt vmcnt(7)
    v_perm_b32 v160, v228, v224, s46
    v_perm_b32 v164, v228, v224, s47
    v_perm_b32 v168, v229, v225, s46
    v_perm_b32 v172, v229, v225, s47
    v_perm_b32 v176, v230, v226, s46
    v_perm_b32 v180, v230, v226, s47
    v_perm_b32 v184, v231, v227, s46
    v_perm_b32 v188, v231, v227, s47
    s_waitcnt vmcnt(5)
    v_perm_b32 v161, v236, v232, s46
    v_perm_b32 v165, v236, v232, s47
    v_perm_b32 v169, v237, v233, s46
    v_perm_b32 v173, v237, v233, s47
    v_perm_b32 v177, v238, v234, s46
    v_perm_b32 v181, v238, v234, s47
    v_perm_b32 v185, v239, v235, s46
    v_perm_b32 v189, v239, v235, s47
    s_waitcnt vmcnt(3)
    v_perm_b32 v162, v244, v240, s46
    v_perm_b32 v166, v244, v240, s47
    v_perm_b32 v170, v245, v241, s46
    v_perm_b32 v174, v245, v241, s47
    v_perm_b32 v178, v246, v242, s46
    v_perm_b32 v182, v246, v242, s47
    v_perm_b32 v186, v247, v243, s46
    v_perm_b32 v190, v247, v243, s47
    s_waitcnt vmcnt(1)
    v_perm_b32 v163, v252, v248, s46
    v_perm_b32 v167, v252, v248, s47
    v_perm_b32 v171, v253, v249, s46
    v_perm_b32 v175, v253, v249, s47
    v_perm_b32 v179, v254, v250, s46
    v_perm_b32 v183, v254, v250, s47
    v_perm_b32 v187, v255, v251, s46
    v_perm_b32 v191, v255, v251, s47
    ds_write_b128 v30, v[160:163] offset:0
    ds_write_b128 v30, v[164:167] offset:144
    ds_write_b128 v30, v[168:171] offset:288
    ds_write_b128 v30, v[172:175] offset:432
    ds_write_b128 v30, v[176:179] offset:576
    ds_write_b128 v30, v[180:183] offset:720
    ds_write_b128 v30, v[184:187] offset:864
    ds_write_b128 v30, v[188:191] offset:1008

    s_cmp_lg_u32 s7, 0
    s_cbranch_scc1 Low_79

    s_lshl_b32 s55, s4, 8
    s_add_u32 s55, s55, 0x1b0000
    v_and_b32 v200, 31, v0
    v_lshlrev_b32 v200, 3, v200
    v_add_u32 v200, s55, v200

    s_add_u32 s56, s54, 1
    s_mov_b32 s53, 0
Lp_84:
    buffer_load_dwordx2 v[202:203], v200, s[12:15], 0 offen sc1
    s_waitcnt vmcnt(0)
    v_cmp_ne_u32 vcc, s56, v202
    s_cbranch_vccz Lpd_85
    s_add_u32 s53, s53, 1
    s_cmp_lt_u32 s53, 64
    s_cbranch_scc1 Lp_84
Lpd_85:
    s_cbranch_vccnz Lhs_82
    v_cmp_ne_u32 vcc, s62, v203
    s_mov_b32 s10, 1
    s_cbranch_vccz Lhs_81
    s_branch Lhs_83
Lhs_82:

    s_lshl_b32 s55, s4, 12
    s_add_u32 s55, s55, 0x1a0000
    v_and_b32 v208, 31, v0
    v_lshlrev_b32 v208, 7, v208
    v_add_u32 v208, s55, v208

    s_mov_b32 s53, 0
Lp_86:
    buffer_load_dwordx2 v[202:203], v208, s[12:15], 0 offen sc1
    s_waitcnt vmcnt(0)
    v_cmp_ne_u32 vcc, s56, v202
    s_cbranch_vccz Lpd_87
    s_add_u32 s53, s53, 1
    s_cmp_lt_u32 s53, s11
    s_cbranch_scc1 Lp_86
    s_mov_b32 s11, 0
Lpd_87:
    v_cmp_ne_u32 vcc, s62, v203
    s_mov_b32 s10, 1
    s_cbranch_vccz Lhs_81
Lhs_83:
    s_mov_b32 s10, 0
    s_add_u32 s48, s48, 0x800000

    s_lshl_b32 s55, s4, 12
    s_add_u32 s55, s55, 0x1a8080
    v_and_b32 v214, 7, v0
    v_lshlrev_b32 v214, 9, v214
    v_add_u32 v214, s55, v214

    s_add_u32 s56, s54, 1
    s_mov_b32 s53, 0
Lp_88:
    buffer_load_dwordx2 v[202:203], v214, s[12:15], 0 offen sc1
    s_waitcnt vmcnt(0)
    v_cmp_ne_u32 vcc, s56, v202
    s_cbranch_vccz Lpd_89
    s_add_u32 s53, s53, 1
    s_cmp_lt_u32 s53, s11
    s_cbranch_scc1 Lp_88
    s_mov_b32 s11, 0
Lpd_89:
Lhs_81:
Lhw_80:
    v_mov_b32 v30, s10
    v_mov_b32 v31, 136260
    ds_write_b32 v31, v30
    s_lshl_b32 s48, s4, 19
    s_add_u32 s48, s48, 0x200000
    s_waitcnt lgkmcnt(0)
Low_79:
    v_and_b32 v28, 15, v0
    v_lshrrev_b32 v29, 4, v0

    s_mul_i32 s55, s59, 9216
    s_add_u32 s55, s55, s39
    v_mul_u32_u24 v31, 576, v28
    v_add_u32 v31, s55, v31
    v_lshrrev_b32 v30, 1, v28
    v_xor_b32 v30, s59, v30
    v_xor_b32 v30, v30, v29
    v_lshl_add_u32 v32, v30, 4, v31
    v_xor_b32 v30, 4, v30
    v_lshl_add_u32 v33, v30, 4, v31

    s_waitcnt lgkmcnt(0)
    s_barrier
    v_mov_b32 v30, 136260
    ds_read_b32 v30, v30
    s_waitcnt lgkmcnt(0)
    v_readfirstlane_b32 s10, v30
    s_nop 0
    s_cmp_eq_u32 s10, 0
    s_cselect_b32 s55, 0x800000, 0
    s_add_u32 s48, s48, s55
    ds_read_b128 v[96:99], v32 offset:0
    ds_read_b128 v[100:103], v33 offset:0
    ds_read_b128 v[104:107], v32 offset:144
    ds_read_b128 v[108:111], v33 offset:144
    ds_read_b128 v[112:115], v32 offset:288
    ds_read_b128 v[116:119], v33 offset:288
    ds_read_b128 v[120:123], v32 offset:432
    ds_read_b128 v[124:127], v33 offset:432
    v_add_u32 v34, 73728, v32
    v_add_u32 v35, 73728, v33
    ds_read_b128 v[64:67], v34 offset:0
    ds_read_b128 v[68:71], v35 offset:0
    ds_read_b128 v[72:75], v34 offset:144
    ds_read_b128 v[76:79], v35 offset:144
    ds_read_b128 v[80:83], v34 offset:288
    ds_read_b128 v[84:87], v35 offset:288
    ds_read_b128 v[88:91], v34 offset:432
    ds_read_b128 v[92:95], v35 offset:432
    s_waitcnt vmcnt(0) lgkmcnt(0)
    v_mov_b32 v192, 0x3f803f80
    v_mov_b32 v193, 0x3f803f80
    v_mov_b32 v194, 0x3f803f80
    v_mov_b32 v195, 0x3f803f80
    s_nop 1
    v_mfma_f32_16x16x32_bf16 v[32:35], v[192:195], v[96:99], 0
    v_mfma_f32_16x16x32_bf16 v[36:39], v[192:195], v[104:107], 0
    v_mfma_f32_16x16x32_bf16 v[40:43], v[192:195], v[112:115], 0
    v_mfma_f32_16x16x32_bf16 v[44:47], v[192:195], v[120:123], 0
    v_mfma_f32_16x16x32_bf16 v[32:35], v[192:195], v[100:103], v[32:35]
    v_mfma_f32_16x16x32_bf16 v[36:39], v[192:195], v[108:111], v[36:39]
    v_mfma_f32_16x16x32_bf16 v[40:43], v[192:195], v[116:119], v[40:43]
    v_mfma_f32_16x16x32_bf16 v[44:47], v[192:195], v[124:127], v[44:47]
    s_add_u32 s57, s48, 0xa000
    s_nop 4
    v_cvt_pk_bf16_f32 v206, v32, v36
    s_nop 0
    v_cvt_pk_bf16_f32 v207, v40, v44
    s_cmp_eq_u32 s10, 0
    s_cbranch_scc1 Lst_90
    s_mov_b64 exec, 0xffff
    buffer_store_dwordx2 v[206:207], v2, s[12:15], s57 offen
    s_mov_b64 exec, -1
    s_branch Lst_91
Lst_90:
    s_mov_b64 exec, 0xffff
    buffer_store_dwordx2 v[206:207], v2, s[12:15], s57 offen sc1
    s_mov_b64 exec, -1
Lst_91:
    s_mov_b32 s32, 0
    s_add_u32 s57, s48, 0x0

L_qP:
    s_barrier
    s_mov_b32 exec_lo, 0x11111111
    s_mov_b32 exec_hi, 0x11111111
    ds_read_b128 v[192:195], v1
    ds_read_b128 v[196:199], v1 offset:64
    s_mov_b64 exec, -1
    s_waitcnt lgkmcnt(1)
    v_mfma_f32_16x16x32_bf16 v[224:227], v[192:195], v[96:99], 0
    v_mfma_f32_16x16x32_bf16 v[228:231], v[192:195], v[104:107], 0
    v_mfma_f32_16x16x32_bf16 v[232:235], v[192:195], v[112:115], 0
    v_mfma_f32_16x16x32_bf16 v[236:239], v[192:195], v[120:123], 0
    s_waitcnt lgkmcnt(0)
    v_mfma_f32_16x16x32_bf16 v[224:227], v[196:199], v[100:103], v[224:227]
    v_mfma_f32_16x16x32_bf16 v[228:231], v[196:199], v[108:111], v[228:231]
    v_mfma_f32_16x16x32_bf16 v[232:235], v[196:199], v[116:119], v[232:235]
    v_mfma_f32_16x16x32_bf16 v[236:239], v[196:199], v[124:127], v[236:239]
    s_nop 5
    v_cvt_pk_bf16_f32 v200, v224, v228
    s_nop 0
    v_cvt_pk_bf16_f32 v201, v232, v236
    s_cmp_eq_u32 s10, 0
    s_cbranch_scc1 Lst_92
    buffer_store_dwordx2 v[200:201], v2, s[12:15], s57 offen
    s_branch Lst_93
Lst_92:
    buffer_store_dwordx2 v[200:201], v2, s[12:15], s57 offen sc1
Lst_93:
    s_add_u32 s57, s57, 32768
    s_cmp_eq_u32 s32, 0
    s_cselect_b32 s55, 94208, 0
    s_add_u32 s57, s57, s55
    v_mov_b32 v192, -1
    v_mov_b32 v193, -1
    s_barrier
    s_cmp_eq_u32 s32, 2
    s_cbranch_scc1 Lcq_94
    s_cmp_eq_u32 s10, 0
    s_cbranch_scc1 Lst_95
    buffer_store_dwordx2 v[192:193], v2, s[12:15], s57 offen
    s_branch Lst_96
Lst_95:
    buffer_store_dwordx2 v[192:193], v2, s[12:15], s57 offen sc1
Lst_96:
    s_waitcnt vmcnt(0)
Lcq_94:
    s_barrier

    s_cmp_eq_u32 s32, 2
    s_cbranch_scc1 L_qPe
L_qPn:
    s_cmp_lg_u32 s32, 0
    s_cbranch_scc1 Lca_97
    s_mov_b32 s56, s57
    v_mov_b32 v192, 0x3f803f80
    v_mov_b32 v193, 0x3f803f80
    v_mov_b32 v194, 0x3f803f80
    v_mov_b32 v195, 0x3f803f80
    s_nop 1
    v_mfma_f32_16x16x32_bf16 v[32:35], v[192:195], v[64:67], 0
    v_mfma_f32_16x16x32_bf16 v[36:39], v[192:195], v[72:75], 0
    v_mfma_f32_16x16x32_bf16 v[40:43], v[192:195], v[80:83], 0
    v_mfma_f32_16x16x32_bf16 v[44:47], v[192:195], v[88:91], 0
    v_mfma_f32_16x16x32_bf16 v[32:35], v[192:195], v[68:71], v[32:35]
    v_mfma_f32_16x16x32_bf16 v[36:39], v[192:195], v[76:79], v[36:39]
    v_mfma_f32_16x16x32_bf16 v[40:43], v[192:195], v[84:87], v[40:43]
    v_mfma_f32_16x16x32_bf16 v[44:47], v[192:195], v[92:95], v[44:47]
    s_add_u32 s57, s48, 0x8000
    s_nop 4
    v_cvt_pk_bf16_f32 v204, v32, v36
    s_nop 0
    v_cvt_pk_bf16_f32 v205, v40, v44
    s_cmp_eq_u32 s10, 0
    s_cbranch_scc1 Lst_98
    s_mov_b64 exec, 0xffff
    buffer_store_dwordx2 v[204:205], v2, s[12:15], s57 offen
    s_mov_b64 exec, -1
    s_branch Lst_99
Lst_98:
    s_mov_b64 exec, 0xffff
    buffer_store_dwordx2 v[204:205], v2, s[12:15], s57 offen sc1
    s_mov_b64 exec, -1
Lst_99:
    s_mov_b32 s57, s56
    s_nop 7
Lca_97:
    s_add_u32 s32, s32, 1
    v_swap_b32 v64, v96
    v_swap_b32 v65, v97
    v_swap_b32 v66, v98
    v_swap_b32 v67, v99
    v_swap_b32 v68, v100
    v_swap_b32 v69, v101
    v_swap_b32 v70, v102
    v_swap_b32 v71, v103
    v_swap_b32 v72, v104
    v_swap_b32 v73, v105
    v_swap_b32 v74, v106
    v_swap_b32 v75, v107
    v_swap_b32 v76, v108
    v_swap_b32 v77, v109
    v_swap_b32 v78, v110
    v_swap_b32 v79, v111
    v_swap_b32 v80, v112
    v_swap_b32 v81, v113
    v_swap_b32 v82, v114
    v_swap_b32 v83, v115
    v_swap_b32 v84, v116
    v_swap_b32 v85, v117
    v_swap_b32 v86, v118
    v_swap_b32 v87, v119
    v_swap_b32 v88, v120
    v_swap_b32 v89, v121
    v_swap_b32 v90, v122
    v_swap_b32 v91, v123
    v_swap_b32 v92, v124
    v_swap_b32 v93, v125
    v_swap_b32 v94, v126
    v_swap_b32 v95, v127
    s_branch L_qP
L_qPe:

    s_or_b32 s55, s4, s6
    s_or_b32 s55, s55, s7
    s_cmp_lg_u32 s55, 0
    s_cbranch_scc1 L_fin
    v_mov_b32 v192, 0x1c0000
    s_add_u32 s56, s54, 1
    v_mov_b32 v193, s56
    s_mov_b64 exec, 1
    buffer_store_dword v193, v192, s[12:15], 0 offen sc1
    s_mov_b64 exec, -1

    s_endpgm
.p2align 12
L_pg6:
L_QG:
    s_lshr_b32 s9, s7, 2
    s_mul_i32 s39, s9, 36864
    s_barrier
    v_and_b32 v28, 15, v0
    v_lshrrev_b32 v29, 4, v0

    v_lshrrev_b32 v201, 2, v28
    v_and_b32 v202, 7, v0
    v_lshlrev_b32 v203, 4, v0
    v_mul_u32_u24 v1, 192, v201
    v_lshl_add_u32 v1, v29, 4, v1
    v_add_u32 v1, 135424, v1
    s_lshl_b32 s55, s9, 12
    s_lshr_b32 s56, s59, 1
    s_lshl_b32 s56, s56, 11
    s_add_u32 s55, s55, s56
    s_and_b32 s56, s59, 1
    s_lshl_b32 s56, s56, 7
    s_add_u32 s55, s55, s56
    s_lshl_b32 s56, s6, 8
    s_add_u32 s55, s55, s56
    v_lshlrev_b32 v2, 13, v29
    v_lshl_add_u32 v2, v28, 3, v2
    v_add_u32 v2, s55, v2

    s_lshl_b32 s55, s6, 14
    s_lshl_b32 s56, s59, 11
    s_add_u32 s55, s55, s56
    v_add_u32 v3, s55, v203
    v_lshrrev_b32 v200, 1, v202
    v_mul_u32_u24 v5, 192, v200
    v_and_b32 v203, 1, v0
    v_lshl_add_u32 v5, v203, 4, v5
    v_and_b32 v203, 1, v29
    v_lshl_add_u32 v5, v203, 3, v5
    s_lshl_b32 s55, s59, 5
    s_add_u32 s55, s55, 135424
    v_add_u32 v5, s55, v5
    s_lshl_b32 s55, s6, 5
    s_lshl_b32 s56, s59, 3
    s_add_u32 s55, s55, s56
    v_lshlrev_b32 v6, 8, v200
    v_lshl_add_u32 v6, v203, 2, v6
    v_add_u32 v6, s55, v6
    s_lshl_b32 s55, s59, 2
    s_and_b32 s56, s6, 3
    s_add_u32 s55, s55, s56
    s_lshl_b32 s55, s55, 7
    s_add_u32 s55, s55, 4
    v_and_b32 v7, 3, v0
    v_lshlrev_b32 v7, 3, v7
    v_add_u32 v7, s55, v7

    v_and_b32 v203, 1, v28
    v_lshlrev_b32 v203, 4, v203
    v_mov_b32 v200, 0xffff
    v_lshlrev_b32 v200, v203, v200
    v_lshrrev_b32 v203, 1, v28

    v_cmp_eq_u32 vcc, 0, v203
    s_nop 1
    v_cndmask_b32 v24, 0, v200, vcc
    v_cmp_eq_u32 vcc, 1, v203
    s_nop 1
    v_cndmask_b32 v25, 0, v200, vcc
    v_cmp_eq_u32 vcc, 2, v203
    s_nop 1
    v_cndmask_b32 v26, 0, v200, vcc
    v_cmp_eq_u32 vcc, 3, v203
    s_nop 1
    v_cndmask_b32 v27, 0, v200, vcc

    v_and_b32 v30, 31, v0
    v_lshrrev_b32 v31, 3, v30
    v_xor_b32 v31, v31, v30
    v_lshrrev_b32 v29, 5, v0
    v_xor_b32 v31, v31, v29
    s_lshl_b32 s55, s59, 1
    v_xor_b32 v31, s55, v31
    v_and_b32 v31, 7, v31
    v_mul_u32_u24 v30, 1152, v30
    v_lshl_add_u32 v30, v31, 4, v30
    v_add_u32 v30, s39, v30

    s_waitcnt vmcnt(6)
    v_perm_b32 v160, v228, v224, s46
    v_perm_b32 v164, v228, v224, s47
    v_perm_b32 v168, v229, v225, s46
    v_perm_b32 v172, v229, v225, s47
    v_perm_b32 v176, v230, v226, s46
    v_perm_b32 v180, v230, v226, s47
    v_perm_b32 v184, v231, v227, s46
    v_perm_b32 v188, v231, v227, s47
    s_waitcnt vmcnt(4)
    v_perm_b32 v161, v236, v232, s46
    v_perm_b32 v165, v236, v232, s47
    v_perm_b32 v169, v237, v233, s46
    v_perm_b32 v173, v237, v233, s47
    v_perm_b32 v177, v238, v234, s46
    v_perm_b32 v181, v238, v234, s47
    v_perm_b32 v185, v239, v235, s46
    v_perm_b32 v189, v239, v235, s47
    s_waitcnt vmcnt(2)
    v_perm_b32 v162, v244, v240, s46
    v_perm_b32 v166, v244, v240, s47
    v_perm_b32 v170, v245, v241, s46
    v_perm_b32 v174, v245, v241, s47
    v_perm_b32 v178, v246, v242, s46
    v_perm_b32 v182, v246, v242, s47
    v_perm_b32 v186, v247, v243, s46
    v_perm_b32 v190, v247, v243, s47
    s_waitcnt vmcnt(0)
    v_perm_b32 v163, v252, v248, s46
    v_perm_b32 v167, v252, v248, s47
    v_perm_b32 v171, v253, v249, s46
    v_perm_b32 v175, v253, v249, s47
    v_perm_b32 v179, v254, v250, s46
    v_perm_b32 v183, v254, v250, s47
    v_perm_b32 v187, v255, v251, s46
    v_perm_b32 v191, v255, v251, s47
    ds_write_b128 v30, v[160:163] offset:0
    ds_write_b128 v30, v[164:167] offset:144
    ds_write_b128 v30, v[168:171] offset:288
    ds_write_b128 v30, v[172:175] offset:432
    ds_write_b128 v30, v[176:179] offset:576
    ds_write_b128 v30, v[180:183] offset:720
    ds_write_b128 v30, v[184:187] offset:864
    ds_write_b128 v30, v[188:191] offset:1008
    v_and_b32 v28, 15, v0
    v_lshrrev_b32 v29, 4, v0

    s_mul_i32 s55, s59, 9216
    s_add_u32 s55, s55, s39
    v_mul_u32_u24 v31, 576, v28
    v_add_u32 v31, s55, v31
    v_lshrrev_b32 v30, 1, v28
    v_xor_b32 v30, s59, v30
    v_xor_b32 v30, v30, v29
    v_lshl_add_u32 v32, v30, 4, v31
    v_xor_b32 v30, 4, v30
    v_lshl_add_u32 v33, v30, 4, v31

    s_waitcnt lgkmcnt(0)
    s_barrier
    ds_read_b128 v[64:67], v32 offset:0
    ds_read_b128 v[68:71], v33 offset:0
    ds_read_b128 v[72:75], v32 offset:144
    ds_read_b128 v[76:79], v33 offset:144
    ds_read_b128 v[80:83], v32 offset:288
    ds_read_b128 v[84:87], v33 offset:288
    ds_read_b128 v[88:91], v32 offset:432
    ds_read_b128 v[92:95], v33 offset:432
    s_waitcnt lgkmcnt(0)
    s_mov_b32 exec_lo, 0x11111111
    s_mov_b32 exec_hi, 0x11111111
    ds_read_b128 v[192:195], v1
    ds_read_b128 v[196:199], v1 offset:64
    s_mov_b64 exec, -1
    s_waitcnt lgkmcnt(1)
    v_mfma_f32_16x16x32_bf16 v[224:227], v[192:195], v[64:67], 0
    v_mfma_f32_16x16x32_bf16 v[228:231], v[192:195], v[72:75], 0
    v_mfma_f32_16x16x32_bf16 v[232:235], v[192:195], v[80:83], 0
    v_mfma_f32_16x16x32_bf16 v[236:239], v[192:195], v[88:91], 0
    s_waitcnt lgkmcnt(0)
    v_mfma_f32_16x16x32_bf16 v[224:227], v[196:199], v[68:71], v[224:227]
    v_mfma_f32_16x16x32_bf16 v[228:231], v[196:199], v[76:79], v[228:231]
    v_mfma_f32_16x16x32_bf16 v[232:235], v[196:199], v[84:87], v[232:235]
    v_mfma_f32_16x16x32_bf16 v[236:239], v[196:199], v[92:95], v[236:239]
    s_add_u32 s55, s54, 1
    s_and_b32 s55, s55, 0xbfffbfff
    v_mov_b32 v201, s55
    v_mov_b32 v203, s55
    s_nop 1
    v_cvt_pk_bf16_f32 v200, v224, v228
    s_nop 0
    v_cvt_pk_bf16_f32 v202, v232, v236
    v_lshlrev_b32 v9, 1, v2
    s_add_u32 s52, s48, 0x50000
    buffer_store_dwordx4 v[200:203], v9, s[12:15], s52 offen

    v_bfe_u32 v131, v0, 1, 2
    v_lshlrev_b32 v131, 10, v131
    v_and_b32 v30, 1, v0
    v_lshl_add_u32 v131, v30, 4, v131
    v_bfe_u32 v30, v0, 4, 1
    v_lshl_add_u32 v131, v30, 3, v131
    s_lshl_b32 s55, s6, 7
    s_lshl_b32 s56, s59, 5
    s_add_u32 s55, s55, s56
    v_add_u32 v131, s55, v131

    global_load_dwordx2 v[128:129], v131, s[44:45]

    s_lshl_b32 s3, s4, 19
    s_and_b32 s55, s6, 1
    s_lshl_b32 s55, s55, 18
    s_add_u32 s3, s3, s55
    s_lshl_b32 s55, s59, 16
    s_add_u32 s3, s3, s55
    s_and_b32 s55, s6, 6
    s_add_u32 s55, s55, s9
    s_lshl_b32 s55, s55, 7
    s_add_u32 s3, s3, s55
    v_lshrrev_b32 v16, 3, v0
    v_lshlrev_b32 v16, 10, v16
    v_and_b32 v30, 7, v0
    v_lshl_add_u32 v16, v30, 4, v16
    v_add_u32 v16, s3, v16

    s_barrier
    s_mov_b32 s52, 32768
    buffer_load_dwordx4 v[12:15], v16, s[20:23], s52 offen
    s_mov_b32 s52, 40960
    buffer_load_dwordx4 v[12:15], v16, s[20:23], s52 offen
    s_mov_b32 s52, 49152
    buffer_load_dwordx4 v[12:15], v16, s[20:23], s52 offen
    s_mov_b32 s52, 57344
    buffer_load_dwordx4 v[12:15], v16, s[20:23], s52 offen
    s_barrier
    s_mov_b32 s52, 0
    buffer_load_dwordx4 v[224:227], v4, s[24:27], s52 offen nt
    s_mov_b32 s52, 8192
    buffer_load_dwordx4 v[228:231], v4, s[24:27], s52 offen nt
    s_mov_b32 s52, 16384
    buffer_load_dwordx4 v[232:235], v4, s[24:27], s52 offen nt
    s_mov_b32 s52, 24576
    buffer_load_dwordx4 v[236:239], v4, s[24:27], s52 offen nt
    s_mov_b32 s52, 32768
    buffer_load_dwordx4 v[240:243], v4, s[24:27], s52 offen nt
    s_mov_b32 s52, 40960
    buffer_load_dwordx4 v[244:247], v4, s[24:27], s52 offen nt
    s_mov_b32 s52, 49152
    buffer_load_dwordx4 v[248:251], v4, s[24:27], s52 offen nt
    s_mov_b32 s52, 57344
    buffer_load_dwordx4 v[252:255], v4, s[24:27], s52 offen nt

    v_bfe_u32 v208, v0, 1, 3
    v_lshlrev_b32 v208, 12, v208
    v_and_b32 v30, 1, v0
    v_lshl_add_u32 v208, v30, 9, v208
    s_lshr_b32 s55, s6, 1
    s_lshl_b32 s55, s55, 10
    s_add_u32 s55, s55, 0x1a0080
    v_add_u32 v208, s55, v208

    s_cmp_lg_u32 s7, 6
    s_cbranch_scc1 Low_100
    buffer_load_dword v209, v208, s[12:15], 0 offen sc1
Low_100:
    s_add_u32 s57, s48, 0x1f000
    buffer_load_dwordx2 v[12:13], v2, s[12:15], s57 offen nt

    v_and_b32 v30, 31, v0
    v_lshrrev_b32 v31, 3, v30
    v_xor_b32 v31, v31, v30
    v_lshrrev_b32 v29, 5, v0
    v_xor_b32 v31, v31, v29
    s_lshl_b32 s55, s59, 1
    v_xor_b32 v31, s55, v31
    v_and_b32 v31, 7, v31
    v_mul_u32_u24 v30, 1152, v30
    v_lshl_add_u32 v30, v31, 4, v30
    v_add_u32 v30, s39, v30

    s_waitcnt vmcnt(7)
    v_perm_b32 v160, v228, v224, s46
    v_perm_b32 v164, v228, v224, s47
    v_perm_b32 v168, v229, v225, s46
    v_perm_b32 v172, v229, v225, s47
    v_perm_b32 v176, v230, v226, s46
    v_perm_b32 v180, v230, v226, s47
    v_perm_b32 v184, v231, v227, s46
    v_perm_b32 v188, v231, v227, s47
    s_waitcnt vmcnt(5)
    v_perm_b32 v161, v236, v232, s46
    v_perm_b32 v165, v236, v232, s47
    v_perm_b32 v169, v237, v233, s46
    v_perm_b32 v173, v237, v233, s47
    v_perm_b32 v177, v238, v234, s46
    v_perm_b32 v181, v238, v234, s47
    v_perm_b32 v185, v239, v235, s46
    v_perm_b32 v189, v239, v235, s47
    s_waitcnt vmcnt(3)
    v_perm_b32 v162, v244, v240, s46
    v_perm_b32 v166, v244, v240, s47
    v_perm_b32 v170, v245, v241, s46
    v_perm_b32 v174, v245, v241, s47
    v_perm_b32 v178, v246, v242, s46
    v_perm_b32 v182, v246, v242, s47
    v_perm_b32 v186, v247, v243, s46
    v_perm_b32 v190, v247, v243, s47
    s_waitcnt vmcnt(1)
    v_perm_b32 v163, v252, v248, s46
    v_perm_b32 v167, v252, v248, s47
    v_perm_b32 v171, v253, v249, s46
    v_perm_b32 v175, v253, v249, s47
    v_perm_b32 v179, v254, v250, s46
    v_perm_b32 v183, v254, v250, s47
    v_perm_b32 v187, v255, v251, s46
    v_perm_b32 v191, v255, v251, s47
    ds_write_b128 v30, v[160:163] offset:0
    ds_write_b128 v30, v[164:167] offset:144
    ds_write_b128 v30, v[168:171] offset:288
    ds_write_b128 v30, v[172:175] offset:432
    ds_write_b128 v30, v[176:179] offset:576
    ds_write_b128 v30, v[180:183] offset:720
    ds_write_b128 v30, v[184:187] offset:864
    ds_write_b128 v30, v[188:191] offset:1008
    s_cmp_lg_u32 s7, 6
    s_cbranch_scc1 Low_101
    s_add_u32 s56, s54, 1
    s_mov_b32 s53, 0
    s_branch Lpw_104
Lp_102:
    buffer_load_dword v209, v208, s[12:15], 0 offen sc1
Lpw_104:
    s_waitcnt vmcnt(0)
    v_cmp_ne_u32 vcc, s56, v209
    s_cbranch_vccz Lpd_103
    s_add_u32 s53, s53, 1
    s_cmp_lt_u32 s53, s11
    s_cbranch_scc1 Lp_102
    s_mov_b32 s11, 0
Lpd_103:
Low_101:
    v_and_b32 v28, 15, v0
    v_lshrrev_b32 v29, 4, v0

    s_mul_i32 s55, s59, 9216
    s_add_u32 s55, s55, s39
    v_mul_u32_u24 v31, 576, v28
    v_add_u32 v31, s55, v31
    v_lshrrev_b32 v30, 1, v28
    v_xor_b32 v30, s59, v30
    v_xor_b32 v30, v30, v29
    v_lshl_add_u32 v32, v30, 4, v31
    v_xor_b32 v30, 4, v30
    v_lshl_add_u32 v33, v30, 4, v31

    s_waitcnt lgkmcnt(0)
    s_barrier
    v_mov_b32 v30, 136260
    ds_read_b32 v30, v30
    s_waitcnt lgkmcnt(0)
    v_readfirstlane_b32 s10, v30
    s_nop 0
    s_cmp_eq_u32 s10, 0
    s_cselect_b32 s55, 0x800000, 0
    s_add_u32 s48, s48, s55
    s_cmp_lg_u32 s10, 0
    s_cbranch_scc1 Lq2_105
    s_add_u32 s52, s48, 0x50000
    buffer_store_dwordx4 v[200:203], v9, s[12:15], s52 offen sc1
    s_nop 1
Lq2_105:
    ds_read_b128 v[96:99], v32 offset:0
    ds_read_b128 v[100:103], v33 offset:0
    ds_read_b128 v[104:107], v32 offset:144
    ds_read_b128 v[108:111], v33 offset:144
    ds_read_b128 v[112:115], v32 offset:288
    ds_read_b128 v[116:119], v33 offset:288
    ds_read_b128 v[120:123], v32 offset:432
    ds_read_b128 v[124:127], v33 offset:432
    s_waitcnt vmcnt(0) lgkmcnt(0)
    v_mov_b32 v192, 0x3f803f80
    v_mov_b32 v193, 0x3f803f80
    v_mov_b32 v194, 0x3f803f80
    v_mov_b32 v195, 0x3f803f80
    s_nop 1
    v_mfma_f32_16x16x32_bf16 v[32:35], v[192:195], v[96:99], 0
    v_mfma_f32_16x16x32_bf16 v[36:39], v[192:195], v[104:107], 0
    v_mfma_f32_16x16x32_bf16 v[40:43], v[192:195], v[112:115], 0
    v_mfma_f32_16x16x32_bf16 v[44:47], v[192:195], v[120:123], 0
    v_mfma_f32_16x16x32_bf16 v[32:35], v[192:195], v[100:103], v[32:35]
    v_mfma_f32_16x16x32_bf16 v[36:39], v[192:195], v[108:111], v[36:39]
    v_mfma_f32_16x16x32_bf16 v[40:43], v[192:195], v[116:119], v[40:43]
    v_mfma_f32_16x16x32_bf16 v[44:47], v[192:195], v[124:127], v[44:47]
    s_add_u32 s57, s48, 0xa000
    s_nop 4
    v_cvt_pk_bf16_f32 v206, v32, v36
    s_nop 0
    v_cvt_pk_bf16_f32 v207, v40, v44
    s_cmp_eq_u32 s10, 0
    s_cbranch_scc1 Lst_106
    s_mov_b64 exec, 0xffff
    buffer_store_dwordx2 v[206:207], v2, s[12:15], s57 offen
    s_mov_b64 exec, -1
    s_branch Lst_107
Lst_106:
    s_mov_b64 exec, 0xffff
    buffer_store_dwordx2 v[206:207], v2, s[12:15], s57 offen sc1
    s_mov_b64 exec, -1
Lst_107:
    s_mov_b32 s32, 0
    s_add_u32 s57, s48, 0x0
    s_add_u32 s33, s48, 0xc000
    s_add_u32 s35, s48, 0xe000
    s_mov_b32 s34, 0x100000
    s_cmp_eq_u32 s4, s6
    s_cselect_b32 s36, 0, 0
    s_mov_b32 s37, 0

    s_branch L_qG
L_qGe:
    s_endpgm
L_qG:
    s_mov_b32 s52, s34
    v_mov_b32 v30, 136256
    ds_read_b32 v30, v30
    s_waitcnt lgkmcnt(0)
    v_readfirstlane_b32 s55, v30
    s_nop 0
    s_and_b32 s55, s55, 0x2000
    s_add_u32 s52, s52, s55
    s_mov_b32 s53, 0
Lp_108:
    buffer_load_dword v192, v7, s[12:15], s33 offen sc1
    s_waitcnt vmcnt(0)
    v_cmp_ne_u32 vcc, -1, v192
    s_nop 0
    s_cmp_eq_u64 vcc, 0
    s_cselect_b64 vcc, -1, 0
    s_cbranch_vccz Lpd_109
    s_add_u32 s53, s53, 1
    s_cmp_lt_u32 s53, s11
    s_cbranch_scc1 Lp_108
    s_mov_b32 s11, 0
Lpd_109:
    s_mov_b32 s53, 0
    buffer_load_dwordx4 v[44:47], v3, s[12:15], s52 offen offset:0 sc1
    buffer_load_dwordx4 v[48:51], v3, s[12:15], s52 offen offset:1024 sc1
    v_and_b32 v60, 0x3f803f80, v24
    v_and_b32 v61, 0x3f803f80, v25
    v_and_b32 v62, 0x3f803f80, v26
    v_and_b32 v63, 0x3f803f80, v27
    v_lshlrev_b32 v132, 16, v128
    v_and_b32 v133, 0xffff0000, v128
    v_lshlrev_b32 v134, 16, v129
    v_and_b32 v135, 0xffff0000, v129
    buffer_load_dwordx4 v[52:55], v3, s[12:15], s52 offen offset:0 sc1
    buffer_load_dwordx4 v[56:59], v3, s[12:15], s52 offen offset:1024 sc1
Lx_110:
    s_waitcnt vmcnt(2)
    v_mfma_f32_16x16x32_bf16 v[32:35], v[60:63], v[44:47], 0
    v_mfma_f32_16x16x32_bf16 v[32:35], v[60:63], v[48:51], v[32:35]
    v_max3_u32 v28, v44, v45, v46
    v_max3_u32 v28, v28, v47, v48
    v_max3_u32 v28, v28, v49, v50
    v_max_u32 v28, v28, v51
    v_cmp_eq_u32 vcc, -1, v28
    s_cbranch_vccz Lxd_111
    buffer_load_dwordx4 v[44:47], v3, s[12:15], s52 offen offset:0 sc1
    buffer_load_dwordx4 v[48:51], v3, s[12:15], s52 offen offset:1024 sc1
    s_waitcnt vmcnt(2)
    v_mfma_f32_16x16x32_bf16 v[32:35], v[60:63], v[52:55], 0
    v_mfma_f32_16x16x32_bf16 v[32:35], v[60:63], v[56:59], v[32:35]
    v_max3_u32 v28, v52, v53, v54
    v_max3_u32 v28, v28, v55, v56
    v_max3_u32 v28, v28, v57, v58
    v_max_u32 v28, v28, v59
    v_cmp_eq_u32 vcc, -1, v28
    s_cbranch_vccz Lxd_111
    buffer_load_dwordx4 v[52:55], v3, s[12:15], s52 offen offset:0 sc1
    buffer_load_dwordx4 v[56:59], v3, s[12:15], s52 offen offset:1024 sc1
    s_add_u32 s53, s53, 1
    s_cmp_lt_u32 s53, s11
    s_cbranch_scc1 Lx_110
    s_mov_b32 s11, 0
    s_waitcnt vmcnt(0)
Lxd_111:
    s_nop 1
    v_add_f32_dpp v36, v32, v32 row_ror:8 row_mask:0xf bank_mask:0xf
    v_add_f32_dpp v37, v33, v33 row_ror:8 row_mask:0xf bank_mask:0xf
    v_add_f32_dpp v38, v34, v34 row_ror:8 row_mask:0xf bank_mask:0xf
    v_add_f32_dpp v39, v35, v35 row_ror:8 row_mask:0xf bank_mask:0xf
    v_cvt_pk_bf16_f32 v40, v36, v37
    v_cvt_pk_bf16_f32 v41, v38, v39
    v_lshlrev_b32 v36, 16, v40
    v_and_b32 v37, 0xffff0000, v40
    v_lshlrev_b32 v38, 16, v41
    v_and_b32 v39, 0xffff0000, v41
    v_add_f32 v36, v36, v132
    v_add_f32 v37, v37, v133
    v_add_f32 v38, v38, v134
    v_add_f32 v39, v39, v135
    v_cvt_pk_bf16_f32 v128, v36, v37
    v_cvt_pk_bf16_f32 v129, v38, v39
    s_mov_b32 exec_hi, 0
    ds_write_b64 v5, v[128:129]
    s_mov_b64 exec, s[36:37]
    global_store_dwordx2 v131, v[128:129], s[42:43]
    s_mov_b64 exec, -1
    s_cmp_eq_u32 s32, 3
    s_cbranch_scc1 L_qGe
    s_mov_b32 s52, s35
    v_lshlrev_b32 v132, 16, v128
    v_and_b32 v133, 0xffff0000, v128
    v_lshlrev_b32 v134, 16, v129
    v_and_b32 v135, 0xffff0000, v129
    v_add_f32 v208, v132, v133
    v_mul_f32 v209, v132, v132
    v_add_f32 v210, v134, v135
    v_fmac_f32 v209, v133, v133
    v_add_f32 v208, v208, v210
    v_fmac_f32 v209, v134, v134
    v_fmac_f32 v209, v135, v135
    v_add_f32_dpp v208, v208, v208 quad_perm:[1,0,3,2] row_mask:0xf bank_mask:0xf
    s_nop 0
    v_add_f32_dpp v209, v209, v209 quad_perm:[1,0,3,2] row_mask:0xf bank_mask:0xf
    s_nop 1
    v_permlane16_swap_b32 v208, v209
    v_add_f32 v208, v208, v209
    s_cmp_eq_u32 s10, 0
    s_cbranch_scc1 Lst_112
    s_mov_b64 exec, 0x550055
    buffer_store_dword v208, v6, s[12:15], s52 offen
    s_mov_b64 exec, -1
    s_branch Lst_113
Lst_112:
    s_mov_b64 exec, 0x550055
    buffer_store_dword v208, v6, s[12:15], s52 offen sc1
    s_mov_b64 exec, -1
Lst_113:
    s_waitcnt lgkmcnt(0)
    s_barrier
    s_mov_b32 exec_lo, 0x11111111
    s_mov_b32 exec_hi, 0x11111111
    ds_read_b128 v[192:195], v1
    ds_read_b128 v[196:199], v1 offset:64
    s_mov_b64 exec, -1
    s_waitcnt lgkmcnt(1)
    v_mfma_f32_16x16x32_bf16 v[224:227], v[192:195], v[96:99], 0
    v_mfma_f32_16x16x32_bf16 v[228:231], v[192:195], v[104:107], 0
    v_mfma_f32_16x16x32_bf16 v[232:235], v[192:195], v[112:115], 0
    v_mfma_f32_16x16x32_bf16 v[236:239], v[192:195], v[120:123], 0
    s_waitcnt lgkmcnt(0)
    v_mfma_f32_16x16x32_bf16 v[224:227], v[196:199], v[100:103], v[224:227]
    v_mfma_f32_16x16x32_bf16 v[228:231], v[196:199], v[108:111], v[228:231]
    v_mfma_f32_16x16x32_bf16 v[232:235], v[196:199], v[116:119], v[232:235]
    v_mfma_f32_16x16x32_bf16 v[236:239], v[196:199], v[124:127], v[236:239]
    s_nop 5
    v_cvt_pk_bf16_f32 v200, v224, v228
    s_nop 0
    v_cvt_pk_bf16_f32 v201, v232, v236
    s_cmp_eq_u32 s10, 0
    s_cbranch_scc1 Lst_114
    buffer_store_dwordx2 v[200:201], v2, s[12:15], s57 offen
    s_branch Lst_115
Lst_114:
    buffer_store_dwordx2 v[200:201], v2, s[12:15], s57 offen sc1
Lst_115:
    s_add_u32 s57, s57, 32768
    s_cmp_eq_u32 s32, 0
    s_cselect_b32 s55, 94208, 0
    s_add_u32 s57, s57, s55
    v_mov_b32 v192, -1
    v_mov_b32 v193, -1
    s_barrier
    s_cmp_eq_u32 s32, 2
    s_cbranch_scc1 Lcq_116
    s_cmp_eq_u32 s10, 0
    s_cbranch_scc1 Lst_117
    buffer_store_dwordx2 v[192:193], v2, s[12:15], s57 offen
    s_branch Lst_118
Lst_117:
    buffer_store_dwordx2 v[192:193], v2, s[12:15], s57 offen sc1
Lst_118:
    s_waitcnt vmcnt(0)
Lcq_116:
    s_barrier

    s_cmp_lg_u32 s32, 0
    s_cbranch_scc1 Lca_119
    s_mov_b32 s56, s57
    v_mov_b32 v192, 0x3f803f80
    v_mov_b32 v193, 0x3f803f80
    v_mov_b32 v194, 0x3f803f80
    v_mov_b32 v195, 0x3f803f80
    s_nop 1
    v_mfma_f32_16x16x32_bf16 v[32:35], v[192:195], v[64:67], 0
    v_mfma_f32_16x16x32_bf16 v[36:39], v[192:195], v[72:75], 0
    v_mfma_f32_16x16x32_bf16 v[40:43], v[192:195], v[80:83], 0
    v_mfma_f32_16x16x32_bf16 v[44:47], v[192:195], v[88:91], 0
    v_mfma_f32_16x16x32_bf16 v[32:35], v[192:195], v[68:71], v[32:35]
    v_mfma_f32_16x16x32_bf16 v[36:39], v[192:195], v[76:79], v[36:39]
    v_mfma_f32_16x16x32_bf16 v[40:43], v[192:195], v[84:87], v[40:43]
    v_mfma_f32_16x16x32_bf16 v[44:47], v[192:195], v[92:95], v[44:47]
    s_add_u32 s57, s48, 0x8000
    s_nop 4
    v_cvt_pk_bf16_f32 v204, v32, v36
    s_nop 0
    v_cvt_pk_bf16_f32 v205, v40, v44
    s_cmp_eq_u32 s10, 0
    s_cbranch_scc1 Lst_120
    s_mov_b64 exec, 0xffff
    buffer_store_dwordx2 v[204:205], v2, s[12:15], s57 offen
    s_mov_b64 exec, -1
    s_branch Lst_121
Lst_120:
    s_mov_b64 exec, 0xffff
    buffer_store_dwordx2 v[204:205], v2, s[12:15], s57 offen sc1
    s_mov_b64 exec, -1
Lst_121:
    s_mov_b32 s57, s56
    s_nop 7
Lca_119:
    s_add_u32 s32, s32, 1
    v_swap_b32 v64, v96
    v_swap_b32 v65, v97
    v_swap_b32 v66, v98
    v_swap_b32 v67, v99
    v_swap_b32 v68, v100
    v_swap_b32 v69, v101
    v_swap_b32 v70, v102
    v_swap_b32 v71, v103
    v_swap_b32 v72, v104
    v_swap_b32 v73, v105
    v_swap_b32 v74, v106
    v_swap_b32 v75, v107
    v_swap_b32 v76, v108
    v_swap_b32 v77, v109
    v_swap_b32 v78, v110
    v_swap_b32 v79, v111
    v_swap_b32 v80, v112
    v_swap_b32 v81, v113
    v_swap_b32 v82, v114
    v_swap_b32 v83, v115
    v_swap_b32 v84, v116
    v_swap_b32 v85, v117
    v_swap_b32 v86, v118
    v_swap_b32 v87, v119
    v_swap_b32 v88, v120
    v_swap_b32 v89, v121
    v_swap_b32 v90, v122
    v_swap_b32 v91, v123
    v_swap_b32 v92, v124
    v_swap_b32 v93, v125
    v_swap_b32 v94, v126
    v_swap_b32 v95, v127
    s_add_u32 s33, s33, 2048
    s_add_u32 s35, s35, 1024
    s_add_u32 s34, s34, 131072
    s_cmp_lg_u32 s32, 3
    s_cbranch_scc1 L_qG
    s_mov_b32 s36, 0xff00ff
    s_cmp_eq_u32 s4, s6
    s_cbranch_scc1 L_qG
    s_endpgm

L_fin:
L_end:
    s_endpgm

.section .rodata,"a"
.p2align 6
.amdhsa_kernel interleave_layers__sliding_block_cached__sliding_block_cached__decode_kernel
  .amdhsa_next_free_vgpr 256
  .amdhsa_next_free_sgpr 102
  .amdhsa_accum_offset 256
  .amdhsa_group_segment_fixed_size 0
  .amdhsa_kernarg_size 104
  .amdhsa_user_sgpr_count 2
  .amdhsa_user_sgpr_kernarg_segment_ptr 1
  .amdhsa_system_sgpr_workgroup_id_x 1
.end_amdhsa_kernel
```
